```python
import torch

def _softmax(x, axis=-1):
    return torch.softmax(x, dim=axis)
def _gelu(x):
    return torch.nn.functional.gelu(x, approximate="tanh")
def _silu(x):
    return torch.nn.functional.silu(x)
def _sigmoid(x):
    return torch.sigmoid(x)
def _layernorm(x, axis=-1, eps=1e-5):
    m = x.mean(dim=axis, keepdim=True)
    v = x.var(dim=axis, keepdim=True, unbiased=False)
    return (x - m) / torch.sqrt(v + eps)
def _scatter_add(tgt, idx, src, axis=0):
    return tgt.clone().index_add_(axis, idx, src)
def _segment_sum(src, seg, n):
    out = torch.zeros((n,) + src.shape[1:], dtype=src.dtype)
    return out.index_add_(0, seg, src)
def _pad(x, pw):
    flat = tuple(v for pair in reversed(pw) for v in pair)
    return torch.nn.functional.pad(x, flat)

kernel_name = 'gated_mix__gqa_block_cached__swiglu_ffn__decode'

def setup_inputs():

    _w = (lambda a: (lambda t: t.to(torch.bfloat16) if t.is_floating_point() else t)(torch.as_tensor(a)))
    def _A_setup():
        B, Sq, D = 1, 1, 448
        Hq, Hkv, Sk, Dh = 16, 8, 65536, 256
        assert Hq % Hkv == 0, (Hq, Hkv)
        return {
            "x": _w((lambda *s: torch.randn(*s, dtype=torch.bfloat16) * 0.05)(B, Sq, D)),
            "k_cache": _w((lambda *s: torch.randn(*s, dtype=torch.bfloat16) * 6.4)(B, Hkv, Sk, Dh)),
            "v_cache": _w((lambda *s: torch.randn(*s, dtype=torch.bfloat16) * 0.2)(B, Hkv, Sk, Dh)),
            "wq": _w((lambda *s: torch.randn(*s, dtype=torch.bfloat16) * 6.4)(D, Hq * Dh) * (D ** -0.5)),
            "wo": _w((lambda *s: torch.randn(*s, dtype=torch.bfloat16) * 0.2)(Hq * Dh, D) * ((Hq * Dh) ** -0.5)),
        }
    _A_in = _A_setup()

    def _B_setup():
        B, S, D, F = 1, 1, 448, 1792
        return {
            "x": _w((lambda *s: torch.randn(*s, dtype=torch.bfloat16) * 0.05)(B, S, D)),
            "w_gate": _w((lambda *s: torch.randn(*s, dtype=torch.bfloat16) * 0.05)(D, F)),
            "w_up": _w((lambda *s: torch.randn(*s, dtype=torch.bfloat16) * 0.05)(D, F)),
            "w_down": _w((lambda *s: torch.randn(*s, dtype=torch.bfloat16) * 0.05)(F, D)),
        }
    _B_in = _B_setup()

    return {
        "A_x": _A_in["x"],
        "A_k_cache": _A_in["k_cache"],
        "A_v_cache": _A_in["v_cache"],
        "A_wq": _A_in["wq"],
        "A_wo": _A_in["wo"],
        "B_x": _B_in["x"],
        "B_w_gate": _B_in["w_gate"],
        "B_w_up": _B_in["w_up"],
        "B_w_down": _B_in["w_down"],
        "gate_w": _w((lambda *s: torch.randn(*s, dtype=torch.bfloat16) * 0.05)(448) * 16.0),
    }

def reference(A_x, A_k_cache, A_v_cache, A_wq, A_wo, B_x, B_w_gate, B_w_up, B_w_down, gate_w):
    def _A_ref(x, k_cache, v_cache, wq, wo):
        B, Sq, D = x.shape
        Hq, Dh = 16, 256
        Hkv = k_cache.shape[1]
        rep = Hq // Hkv
        q = (lambda x, *d: x.permute(*d))((x @ wq).reshape(B, Sq, Hq, Dh), 0, 2, 1, 3)
        k = (lambda x, n, axis: torch.repeat_interleave(x, n, dim=axis))(k_cache, rep, axis=1)
        v = (lambda x, n, axis: torch.repeat_interleave(x, n, dim=axis))(v_cache, rep, axis=1)
        scores = torch.einsum("bhqd,bhkd->bhqk", q, k) * (Dh ** -0.5)
        p = _softmax(scores, axis=-1)
        o = torch.einsum("bhqk,bhkd->bhqd", p, v)
        return (lambda x, *d: x.permute(*d))(o, 0, 2, 1, 3).reshape(B, Sq, Hq * Dh) @ wo

    def _B_ref(x, w_gate, w_up, w_down):
        g = _silu(x @ w_gate)
        u = x @ w_up
        return (g * u) @ w_down

    x = A_x
    g = _sigmoid((x * gate_w).sum(-1, keepdims=True))
    a = _A_ref(x, A_k_cache, A_v_cache, A_wq, A_wo)
    b = _B_ref(x, B_w_gate, B_w_up, B_w_down)
    return g * a + (1 - g) * b
```

```asm
; @launch grid=(256,1,1) block=(384,1,1) lds=163840
.amdgcn_target "amdgcn-amd-amdhsa--gfx950"
.text
.globl gated_mix__gqa_block_cached__swiglu_ffn__decode_kernel
.p2align 8
.type gated_mix__gqa_block_cached__swiglu_ffn__decode_kernel,@function
gated_mix__gqa_block_cached__swiglu_ffn__decode_kernel:
    s_cmp_ge_u32 s2, 256
    s_cbranch_scc1 L_exit
    s_load_dwordx16 s[4:19], s[0:1], 0
    s_load_dwordx8 s[20:27], s[0:1], 64
    s_load_dwordx2 s[28:29], s[0:1], 96
    v_lshrrev_b32 v1, 6, v0
    v_and_b32 v0, 63, v0
    v_readfirstlane_b32 s30, v1
    s_lshr_b32 s31, s2, 5
    s_and_b32 s3, s2, 31
    s_mov_b32 s96, 0x400000
    s_cmp_eq_u32 s30, 4
    s_cbranch_scc1 L_master
    s_cmp_eq_u32 s30, 5
    s_cbranch_scc1 L_gather
    s_cmp_eq_u32 s30, 0
    s_cbranch_scc0 L_consumer
    s_setprio 3
    v_lshlrev_b32 v2, 3, v0
    v_add_u32 v2, 162816, v2
    v_mov_b32 v4, -64
    v_mov_b32 v5, -1
    ds_write_b64 v2, v[4:5]
    v_mov_b32 v3, 163328
    s_mov_b64 exec, 1
    v_mov_b32 v20, 0
    v_mov_b32 v21, 1
    v_mov_b32 v22, 2
    v_mov_b32 v23, 0
    v_mov_b32 v24, 0
    v_mov_b32 v25, 0
    ds_write_b128 v3, v[20:23]
    v_mov_b32 v26, 0
    v_mov_b32 v27, 0
    ds_write_b128 v3, v[24:27] offset:16
    ds_write_b64 v3, v[24:25] offset:32
    v_mov_b32 v28, 0xff61b1e6
    v_mov_b32 v29, v28
    ds_write_b64 v3, v[28:29] offset:48
    s_mov_b64 exec, -1
    v_lshrrev_b32 v6, 5, v0
    v_and_b32 v7, 31, v0
    v_lshlrev_b32 v1, 9, v6
    v_add_u32 v24, 0, v6
    v_xor_b32 v24, v24, v7
    v_lshl_add_u32 v8, v24, 4, v1
    v_add_u32 v24, 2, v6
    v_xor_b32 v24, v24, v7
    v_lshl_add_u32 v9, v24, 4, v1
    v_add_u32 v24, 4, v6
    v_xor_b32 v24, v24, v7
    v_lshl_add_u32 v10, v24, 4, v1
    v_add_u32 v24, 6, v6
    v_xor_b32 v24, v24, v7
    v_lshl_add_u32 v11, v24, 4, v1
    v_add_u32 v24, 8, v6
    v_xor_b32 v24, v24, v7
    v_lshl_add_u32 v12, v24, 4, v1
    v_add_u32 v24, 10, v6
    v_xor_b32 v24, v24, v7
    v_lshl_add_u32 v13, v24, 4, v1
    v_add_u32 v24, 12, v6
    v_xor_b32 v24, v24, v7
    v_lshl_add_u32 v14, v24, 4, v1
    v_add_u32 v24, 14, v6
    v_xor_b32 v24, v24, v7
    v_lshl_add_u32 v15, v24, 4, v1
    v_add_u32 v24, 0, v6
    v_lshlrev_b32 v24, 1, v24
    v_xor_b32 v24, v24, v7
    v_lshl_add_u32 v16, v24, 4, v1
    v_add_u32 v24, 2, v6
    v_lshlrev_b32 v24, 1, v24
    v_xor_b32 v24, v24, v7
    v_lshl_add_u32 v17, v24, 4, v1
    v_add_u32 v24, 4, v6
    v_lshlrev_b32 v24, 1, v24
    v_xor_b32 v24, v24, v7
    v_lshl_add_u32 v18, v24, 4, v1
    v_add_u32 v24, 6, v6
    v_lshlrev_b32 v24, 1, v24
    v_xor_b32 v24, v24, v7
    v_lshl_add_u32 v19, v24, 4, v1
    s_lshl_b32 s55, s31, 25
    s_mov_b32 s50, 0
    s_mov_b32 s51, 9
    s_mov_b32 s52, 0
    s_waitcnt lgkmcnt(0)
    s_mov_b32 s32, s6
    s_and_b32 s33, s7, 0xffff
    s_mov_b32 s34, 0x10000000
    s_mov_b32 s35, 0x20000
    s_mov_b32 s36, s8
    s_and_b32 s37, s9, 0xffff
    s_mov_b32 s38, 0x10000000
    s_mov_b32 s39, 0x20000
    s_barrier
    s_add_u32 s49, s3, 1632
L_ld_k:
    s_bfe_u32 s53, s49, 0x30008
    s_lshl_b32 s53, s53, 22
    s_and_b32 s54, s49, 0xff
    s_lshl_b32 s54, s54, 13
    s_add_u32 s53, s53, s54
    s_bfe_u32 s54, s49, 65540
    s_lshl_b32 s54, s54, 21
    s_add_u32 s53, s53, s54
    s_add_u32 s48, s53, s55
    s_xor_b32 s47, s48, 0x200000
    s_cmp_lt_u32 s50, s51
    s_cbranch_scc1 L_ld_go_k
L_ld_spin_k:
    ds_read_b96 v[20:22], v3
    s_waitcnt lgkmcnt(0)
    v_min3_u32 v20, v20, v21, v22
    s_nop 0
    v_readfirstlane_b32 s51, v20
    s_add_u32 s51, s51, 9
    s_cmp_lt_u32 s50, s51
    s_cbranch_scc1 L_ld_go_k
    s_sleep 1
    s_sub_u32 s96, s96, 1
    s_cmp_gt_i32 s96, 0
    s_cbranch_scc1 L_ld_spin_k
L_ld_go_k:
    s_waitcnt vmcnt(18)
    s_add_u32 m0, s52, 0
    s_add_u32 s54, s48, 0
    buffer_load_dwordx4 v8, s[32:35], s54 offen offset:0 nt lds
    buffer_load_dwordx4 v9, s[32:35], s54 offen offset:1024 nt lds
    buffer_load_dwordx4 v10, s[32:35], s54 offen offset:2048 nt lds
    buffer_load_dwordx4 v11, s[32:35], s54 offen offset:3072 nt lds
    s_waitcnt vmcnt(18)
    s_lshl_b32 s53, s50, 1
    s_add_i32 s53, s53, -2
    v_max_i32 v4, s53, v4
    ds_write_b32 v2, v4
    s_add_u32 m0, s52, 4096
    s_add_u32 s54, s48, 4096
    buffer_load_dwordx4 v12, s[32:35], s54 offen offset:0 nt lds
    buffer_load_dwordx4 v13, s[32:35], s54 offen offset:1024 nt lds
    buffer_load_dwordx4 v14, s[32:35], s54 offen offset:2048 nt lds
    buffer_load_dwordx4 v15, s[32:35], s54 offen offset:3072 nt lds
    s_waitcnt vmcnt(18)
    s_add_u32 m0, s52, 8192
    s_add_u32 s54, s47, 0
    buffer_load_dwordx4 v8, s[32:35], s54 offen offset:0 nt lds
    ds_read_b96 v[20:22], v3
    buffer_load_dwordx4 v9, s[32:35], s54 offen offset:1024 nt lds
    buffer_load_dwordx4 v10, s[32:35], s54 offen offset:2048 nt lds
    buffer_load_dwordx4 v11, s[32:35], s54 offen offset:3072 nt lds
    s_waitcnt vmcnt(18)
    s_lshl_b32 s53, s50, 1
    s_add_i32 s53, s53, -1
    v_max_i32 v4, s53, v4
    ds_write_b32 v2, v4
    s_add_u32 m0, s52, 12288
    s_add_u32 s54, s47, 4096
    buffer_load_dwordx4 v12, s[32:35], s54 offen offset:0 nt lds
    buffer_load_dwordx4 v13, s[32:35], s54 offen offset:1024 nt lds
    s_waitcnt lgkmcnt(0)
    v_min3_u32 v20, v20, v21, v22
    buffer_load_dwordx4 v14, s[32:35], s54 offen offset:2048 nt lds
    v_readfirstlane_b32 s51, v20
    s_add_u32 s51, s51, 9
    buffer_load_dwordx4 v15, s[32:35], s54 offen offset:3072 nt lds
    s_add_u32 s50, s50, 1
    s_add_u32 s52, s52, 16384
    s_cmp_eq_u32 s52, 147456
    s_cselect_b32 s52, 0, s52
    s_add_u32 s49, s49, 32
    s_and_b32 s49, s49, 2047
    s_cmp_lt_u32 s50, 64
    s_cbranch_scc1 L_ld_k
    s_add_u32 s49, s3, 0
L_ld_v:
    s_bfe_u32 s53, s49, 0x30008
    s_lshl_b32 s53, s53, 22
    s_and_b32 s54, s49, 0xff
    s_lshl_b32 s54, s54, 13
    s_add_u32 s53, s53, s54
    s_bfe_u32 s54, s49, 65540
    s_lshl_b32 s54, s54, 21
    s_add_u32 s53, s53, s54
    s_add_u32 s48, s53, s55
    s_xor_b32 s47, s48, 0x200000
    s_cmp_lt_u32 s50, s51
    s_cbranch_scc1 L_ld_go_v
L_ld_spin_v:
    ds_read_b96 v[20:22], v3
    s_waitcnt lgkmcnt(0)
    v_min3_u32 v20, v20, v21, v22
    s_nop 0
    v_readfirstlane_b32 s51, v20
    s_add_u32 s51, s51, 9
    s_cmp_lt_u32 s50, s51
    s_cbranch_scc1 L_ld_go_v
    s_sleep 1
    s_sub_u32 s96, s96, 1
    s_cmp_gt_i32 s96, 0
    s_cbranch_scc1 L_ld_spin_v
L_ld_go_v:
    s_waitcnt vmcnt(18)
    s_add_u32 m0, s52, 0
    s_add_u32 s54, s48, 0
    buffer_load_dwordx4 v16, s[36:39], s54 offen offset:0 nt lds
    buffer_load_dwordx4 v17, s[36:39], s54 offen offset:1024 nt lds
    buffer_load_dwordx4 v18, s[36:39], s54 offen offset:2048 nt lds
    buffer_load_dwordx4 v19, s[36:39], s54 offen offset:3072 nt lds
    s_waitcnt vmcnt(18)
    s_lshl_b32 s53, s50, 1
    s_add_i32 s53, s53, -2
    v_max_i32 v4, s53, v4
    ds_write_b32 v2, v4
    s_add_u32 m0, s52, 4096
    s_add_u32 s54, s48, 4096
    buffer_load_dwordx4 v16, s[36:39], s54 offen offset:0 nt lds
    buffer_load_dwordx4 v17, s[36:39], s54 offen offset:1024 nt lds
    buffer_load_dwordx4 v18, s[36:39], s54 offen offset:2048 nt lds
    buffer_load_dwordx4 v19, s[36:39], s54 offen offset:3072 nt lds
    s_waitcnt vmcnt(18)
    s_add_u32 m0, s52, 8192
    s_add_u32 s54, s47, 0
    buffer_load_dwordx4 v16, s[36:39], s54 offen offset:0 nt lds
    ds_read_b96 v[20:22], v3
    buffer_load_dwordx4 v17, s[36:39], s54 offen offset:1024 nt lds
    buffer_load_dwordx4 v18, s[36:39], s54 offen offset:2048 nt lds
    buffer_load_dwordx4 v19, s[36:39], s54 offen offset:3072 nt lds
    s_waitcnt vmcnt(18)
    s_lshl_b32 s53, s50, 1
    s_add_i32 s53, s53, -1
    v_max_i32 v4, s53, v4
    ds_write_b32 v2, v4
    s_add_u32 m0, s52, 12288
    s_add_u32 s54, s47, 4096
    buffer_load_dwordx4 v16, s[36:39], s54 offen offset:0 nt lds
    buffer_load_dwordx4 v17, s[36:39], s54 offen offset:1024 nt lds
    s_waitcnt lgkmcnt(0)
    v_min3_u32 v20, v20, v21, v22
    buffer_load_dwordx4 v18, s[36:39], s54 offen offset:2048 nt lds
    v_readfirstlane_b32 s51, v20
    s_add_u32 s51, s51, 9
    buffer_load_dwordx4 v19, s[36:39], s54 offen offset:3072 nt lds
    s_add_u32 s50, s50, 1
    s_add_u32 s52, s52, 16384
    s_cmp_eq_u32 s52, 147456
    s_cselect_b32 s52, 0, s52
    s_add_u32 s49, s49, 32
    s_and_b32 s49, s49, 2047
    s_cmp_lt_u32 s50, 115
    s_cbranch_scc1 L_ld_v
    s_mul_i32 s58, s31, 16384
    s_add_u32 s58, s58, 262144
    v_mov_b32 v42, s58
    v_add_u32 v43, 4096, v42
    v_mov_b32 v44, 1
    v_lshlrev_b32 v45, 2, v0
    v_add_u32 v47, 161792, v45
    s_mov_b32 s40, s28
    s_and_b32 s41, s29, 0xffff
    s_mov_b32 s42, 0x200000
    s_mov_b32 s43, 0x20000
    s_mul_i32 s56, s31, 53248
    s_add_u32 s56, s56, 393216
    s_mov_b32 s62, -1
    s_mov_b32 s63, 0
L_ld_pw:
    ds_read_b32 v20, v3 offset:24
    ds_read_b32 v46, v47
    s_waitcnt lgkmcnt(0)
    v_readfirstlane_b32 s57, v20
    s_cmp_lg_u32 s57, 0
    s_cbranch_scc1 L_ld_pwd
    s_sleep 1
    s_sub_u32 s96, s96, 1
    s_cmp_gt_i32 s96, 0
    s_cbranch_scc1 L_ld_pw
L_ld_pwd:
    v_readlane_b32 s64, v46, 32
    v_readlane_b32 s65, v46, 33
    s_max_u32 s64, s64, 2
    s_min_u32 s64, s64, 31
    s_sub_u32 s64, s64, 2
    s_add_u32 s67, s64, 1
    s_mov_b32 s66, 0
    v_readlane_b32 s57, v46, s64
    v_readlane_b32 s58, v46, s67
    s_sub_u32 s57, s57, 1048576
    s_sub_u32 s58, s58, 1048576
    v_mov_b32 v40, s57
    v_mov_b32 v41, s58
L_ld_list:
    s_cmp_ge_u32 s66, s64
    s_cbranch_scc1 L_ld_dyn
    v_readlane_b32 s57, v46, s66
    s_add_u32 s66, s66, 1
    s_min_u32 s57, s57, 415
    s_add_u32 s49, s57, 1632
    s_bfe_u32 s53, s49, 0x30008
    s_lshl_b32 s53, s53, 22
    s_and_b32 s54, s49, 0xff
    s_lshl_b32 s54, s54, 13
    s_add_u32 s53, s53, s54
    s_bfe_u32 s54, s49, 65540
    s_lshl_b32 s54, s54, 21
    s_add_u32 s53, s53, s54
    s_add_u32 s48, s53, s55
    s_xor_b32 s47, s48, 0x200000
    s_cmp_lt_u32 s50, s51
    s_cbranch_scc1 L_ld_go_l
L_ld_spin_l:
    ds_read_b96 v[20:22], v3
    s_waitcnt lgkmcnt(0)
    v_min3_u32 v20, v20, v21, v22
    s_nop 0
    v_readfirstlane_b32 s51, v20
    s_add_u32 s51, s51, 9
    s_cmp_lt_u32 s50, s51
    s_cbranch_scc1 L_ld_go_l
    s_sleep 1
    s_sub_u32 s96, s96, 1
    s_cmp_gt_i32 s96, 0
    s_cbranch_scc1 L_ld_spin_l
L_ld_go_l:
    s_lshl_b32 s57, s57, 7
    s_add_u32 s57, s57, s56
    s_lshr_b32 s58, s52, 7
    s_add_u32 m0, s58, 147456
    s_mov_b64 exec, s[62:63]
    buffer_load_dword v45, s[40:43], s57 offen sc1 lds
    s_mov_b64 exec, -1
    s_waitcnt vmcnt(19)
    s_add_u32 m0, s52, 0
    s_add_u32 s54, s48, 0
    buffer_load_dwordx4 v16, s[36:39], s54 offen offset:0 nt lds
    buffer_load_dwordx4 v17, s[36:39], s54 offen offset:1024 nt lds
    buffer_load_dwordx4 v18, s[36:39], s54 offen offset:2048 nt lds
    buffer_load_dwordx4 v19, s[36:39], s54 offen offset:3072 nt lds
    s_waitcnt vmcnt(19)
    s_lshl_b32 s53, s50, 1
    s_add_i32 s53, s53, -2
    v_max_i32 v4, s53, v4
    ds_write_b32 v2, v4
    s_add_u32 m0, s52, 4096
    s_add_u32 s54, s48, 4096
    buffer_load_dwordx4 v16, s[36:39], s54 offen offset:0 nt lds
    buffer_load_dwordx4 v17, s[36:39], s54 offen offset:1024 nt lds
    buffer_load_dwordx4 v18, s[36:39], s54 offen offset:2048 nt lds
    buffer_load_dwordx4 v19, s[36:39], s54 offen offset:3072 nt lds
    s_waitcnt vmcnt(19)
    s_add_u32 m0, s52, 8192
    s_add_u32 s54, s47, 0
    buffer_load_dwordx4 v16, s[36:39], s54 offen offset:0 nt lds
    ds_read_b96 v[20:22], v3
    buffer_load_dwordx4 v17, s[36:39], s54 offen offset:1024 nt lds
    buffer_load_dwordx4 v18, s[36:39], s54 offen offset:2048 nt lds
    buffer_load_dwordx4 v19, s[36:39], s54 offen offset:3072 nt lds
    s_waitcnt vmcnt(19)
    s_lshl_b32 s53, s50, 1
    s_add_i32 s53, s53, -1
    v_max_i32 v4, s53, v4
    ds_write_b32 v2, v4
    s_add_u32 m0, s52, 12288
    s_add_u32 s54, s47, 4096
    buffer_load_dwordx4 v16, s[36:39], s54 offen offset:0 nt lds
    buffer_load_dwordx4 v17, s[36:39], s54 offen offset:1024 nt lds
    s_waitcnt lgkmcnt(0)
    v_min3_u32 v20, v20, v21, v22
    buffer_load_dwordx4 v18, s[36:39], s54 offen offset:2048 nt lds
    v_readfirstlane_b32 s51, v20
    s_add_u32 s51, s51, 9
    buffer_load_dwordx4 v19, s[36:39], s54 offen offset:3072 nt lds
    s_add_u32 s50, s50, 1
    s_add_u32 s52, s52, 16384
    s_cmp_eq_u32 s52, 147456
    s_cselect_b32 s52, 0, s52
    s_branch L_ld_list
L_ld_dyn:
    s_waitcnt vmcnt(21)
    v_readfirstlane_b32 s58, v40
    s_and_b32 s57, s58, 15
    s_andn2_b32 s49, s58, 15
    s_lshl_b32 s49, s49, 1
    s_add_u32 s57, s57, s49
    s_add_u32 s57, s57, s65
    s_cmp_lt_i32 s58, 0
    s_cbranch_scc0 L_ldp1
    s_add_u32 s57, s58, 1048576
    s_min_u32 s57, s57, 415
    s_branch L_ldp1x
L_ldp1:
    s_cmp_ge_u32 s57, 368
    s_cbranch_scc1 L_ld_gin0
L_ldp1x:
    s_add_u32 s49, s57, 1632
    s_bfe_u32 s53, s49, 0x30008
    s_lshl_b32 s53, s53, 22
    s_and_b32 s54, s49, 0xff
    s_lshl_b32 s54, s54, 13
    s_add_u32 s53, s53, s54
    s_bfe_u32 s54, s49, 65540
    s_lshl_b32 s54, s54, 21
    s_add_u32 s53, s53, s54
    s_add_u32 s48, s53, s55
    s_xor_b32 s47, s48, 0x200000
    s_cmp_lt_u32 s50, s51
    s_cbranch_scc1 L_ld_go_d0
L_ld_spin_d0:
    ds_read_b96 v[20:22], v3
    s_waitcnt lgkmcnt(0)
    v_min3_u32 v20, v20, v21, v22
    s_nop 0
    v_readfirstlane_b32 s51, v20
    s_add_u32 s51, s51, 9
    s_cmp_lt_u32 s50, s51
    s_cbranch_scc1 L_ld_go_d0
    s_sleep 1
    s_sub_u32 s96, s96, 1
    s_cmp_gt_i32 s96, 0
    s_cbranch_scc1 L_ld_spin_d0
L_ld_go_d0:
    s_lshl_b32 s57, s57, 7
    s_add_u32 s57, s57, s56
    s_lshr_b32 s58, s52, 7
    s_add_u32 m0, s58, 147456
    s_mov_b64 exec, 1
    global_atomic_add v40, v42, v44, s[28:29] sc0 sc1
    s_mov_b64 exec, s[62:63]
    buffer_load_dword v45, s[40:43], s57 offen sc1 lds
    s_mov_b64 exec, -1
    s_waitcnt vmcnt(21)
    s_lshl_b32 s53, s50, 1
    s_add_i32 s53, s53, -3
    v_max_i32 v4, s53, v4
    ds_write_b32 v2, v4
    s_add_u32 m0, s52, 0
    s_add_u32 s54, s48, 0
    buffer_load_dwordx4 v16, s[36:39], s54 offen offset:0 nt lds
    buffer_load_dwordx4 v17, s[36:39], s54 offen offset:1024 nt lds
    buffer_load_dwordx4 v18, s[36:39], s54 offen offset:2048 nt lds
    buffer_load_dwordx4 v19, s[36:39], s54 offen offset:3072 nt lds
    s_waitcnt vmcnt(21)
    s_add_u32 m0, s52, 4096
    s_add_u32 s54, s48, 4096
    buffer_load_dwordx4 v16, s[36:39], s54 offen offset:0 nt lds
    buffer_load_dwordx4 v17, s[36:39], s54 offen offset:1024 nt lds
    buffer_load_dwordx4 v18, s[36:39], s54 offen offset:2048 nt lds
    buffer_load_dwordx4 v19, s[36:39], s54 offen offset:3072 nt lds
    s_waitcnt vmcnt(21)
    s_lshl_b32 s53, s50, 1
    s_add_i32 s53, s53, -2
    v_max_i32 v4, s53, v4
    ds_write_b32 v2, v4
    s_add_u32 m0, s52, 8192
    s_add_u32 s54, s47, 0
    buffer_load_dwordx4 v16, s[36:39], s54 offen offset:0 nt lds
    ds_read_b96 v[20:22], v3
    buffer_load_dwordx4 v17, s[36:39], s54 offen offset:1024 nt lds
    buffer_load_dwordx4 v18, s[36:39], s54 offen offset:2048 nt lds
    buffer_load_dwordx4 v19, s[36:39], s54 offen offset:3072 nt lds
    s_waitcnt vmcnt(21)
    s_add_u32 m0, s52, 12288
    s_add_u32 s54, s47, 4096
    buffer_load_dwordx4 v16, s[36:39], s54 offen offset:0 nt lds
    buffer_load_dwordx4 v17, s[36:39], s54 offen offset:1024 nt lds
    s_waitcnt lgkmcnt(0)
    v_min3_u32 v20, v20, v21, v22
    buffer_load_dwordx4 v18, s[36:39], s54 offen offset:2048 nt lds
    v_readfirstlane_b32 s51, v20
    s_add_u32 s51, s51, 9
    buffer_load_dwordx4 v19, s[36:39], s54 offen offset:3072 nt lds
    s_add_u32 s50, s50, 1
    s_add_u32 s52, s52, 16384
    s_cmp_eq_u32 s52, 147456
    s_cselect_b32 s52, 0, s52
    s_waitcnt vmcnt(21)
    v_readfirstlane_b32 s58, v41
    s_and_b32 s57, s58, 15
    s_andn2_b32 s49, s58, 15
    s_lshl_b32 s49, s49, 1
    s_add_u32 s57, s57, s49
    s_add_u32 s57, s57, s65
    s_add_u32 s57, s57, 16
    s_cmp_lt_i32 s58, 0
    s_cbranch_scc0 L_ldp2
    s_add_u32 s57, s58, 1048576
    s_min_u32 s57, s57, 415
    s_branch L_ldp2x
L_ldp2:
    s_cmp_ge_u32 s57, 368
    s_cbranch_scc1 L_ld_gin1
L_ldp2x:
    s_add_u32 s49, s57, 1632
    s_bfe_u32 s53, s49, 0x30008
    s_lshl_b32 s53, s53, 22
    s_and_b32 s54, s49, 0xff
    s_lshl_b32 s54, s54, 13
    s_add_u32 s53, s53, s54
    s_bfe_u32 s54, s49, 65540
    s_lshl_b32 s54, s54, 21
    s_add_u32 s53, s53, s54
    s_add_u32 s48, s53, s55
    s_xor_b32 s47, s48, 0x200000
    s_cmp_lt_u32 s50, s51
    s_cbranch_scc1 L_ld_go_d1
L_ld_spin_d1:
    ds_read_b96 v[20:22], v3
    s_waitcnt lgkmcnt(0)
    v_min3_u32 v20, v20, v21, v22
    s_nop 0
    v_readfirstlane_b32 s51, v20
    s_add_u32 s51, s51, 9
    s_cmp_lt_u32 s50, s51
    s_cbranch_scc1 L_ld_go_d1
    s_sleep 1
    s_sub_u32 s96, s96, 1
    s_cmp_gt_i32 s96, 0
    s_cbranch_scc1 L_ld_spin_d1
L_ld_go_d1:
    s_lshl_b32 s57, s57, 7
    s_add_u32 s57, s57, s56
    s_lshr_b32 s58, s52, 7
    s_add_u32 m0, s58, 147456
    s_mov_b64 exec, 1
    global_atomic_add v41, v43, v44, s[28:29] sc0 sc1
    s_mov_b64 exec, s[62:63]
    buffer_load_dword v45, s[40:43], s57 offen sc1 lds
    s_mov_b64 exec, -1
    s_waitcnt vmcnt(21)
    s_lshl_b32 s53, s50, 1
    s_add_i32 s53, s53, -3
    v_max_i32 v4, s53, v4
    ds_write_b32 v2, v4
    s_add_u32 m0, s52, 0
    s_add_u32 s54, s48, 0
    buffer_load_dwordx4 v16, s[36:39], s54 offen offset:0 nt lds
    buffer_load_dwordx4 v17, s[36:39], s54 offen offset:1024 nt lds
    buffer_load_dwordx4 v18, s[36:39], s54 offen offset:2048 nt lds
    buffer_load_dwordx4 v19, s[36:39], s54 offen offset:3072 nt lds
    s_waitcnt vmcnt(21)
    s_add_u32 m0, s52, 4096
    s_add_u32 s54, s48, 4096
    buffer_load_dwordx4 v16, s[36:39], s54 offen offset:0 nt lds
    buffer_load_dwordx4 v17, s[36:39], s54 offen offset:1024 nt lds
    buffer_load_dwordx4 v18, s[36:39], s54 offen offset:2048 nt lds
    buffer_load_dwordx4 v19, s[36:39], s54 offen offset:3072 nt lds
    s_waitcnt vmcnt(21)
    s_lshl_b32 s53, s50, 1
    s_add_i32 s53, s53, -2
    v_max_i32 v4, s53, v4
    ds_write_b32 v2, v4
    s_add_u32 m0, s52, 8192
    s_add_u32 s54, s47, 0
    buffer_load_dwordx4 v16, s[36:39], s54 offen offset:0 nt lds
    ds_read_b96 v[20:22], v3
    buffer_load_dwordx4 v17, s[36:39], s54 offen offset:1024 nt lds
    buffer_load_dwordx4 v18, s[36:39], s54 offen offset:2048 nt lds
    buffer_load_dwordx4 v19, s[36:39], s54 offen offset:3072 nt lds
    s_waitcnt vmcnt(21)
    s_add_u32 m0, s52, 12288
    s_add_u32 s54, s47, 4096
    buffer_load_dwordx4 v16, s[36:39], s54 offen offset:0 nt lds
    buffer_load_dwordx4 v17, s[36:39], s54 offen offset:1024 nt lds
    s_waitcnt lgkmcnt(0)
    v_min3_u32 v20, v20, v21, v22
    buffer_load_dwordx4 v18, s[36:39], s54 offen offset:2048 nt lds
    v_readfirstlane_b32 s51, v20
    s_add_u32 s51, s51, 9
    buffer_load_dwordx4 v19, s[36:39], s54 offen offset:3072 nt lds
    s_add_u32 s50, s50, 1
    s_add_u32 s52, s52, 16384
    s_cmp_eq_u32 s52, 147456
    s_cselect_b32 s52, 0, s52
    s_branch L_ld_dyn
L_ld_greedy:
    s_waitcnt vmcnt(44)
    s_lshl_b32 s53, s50, 1
    s_add_i32 s53, s53, -5
    v_max_i32 v4, s53, v4
    ds_write_b32 v2, v4
    s_waitcnt vmcnt(36)
    s_lshl_b32 s53, s50, 1
    s_add_i32 s53, s53, -4
    v_max_i32 v4, s53, v4
    ds_write_b32 v2, v4
    s_waitcnt vmcnt(35)
    v_readfirstlane_b32 s58, v40
    s_and_b32 s57, s58, 15
    s_andn2_b32 s49, s58, 15
    s_lshl_b32 s49, s49, 1
    s_add_u32 s57, s57, s49
    s_add_u32 s57, s57, s65
L_ld_gin0:
    s_cmp_ge_u32 s57, 416
    s_cbranch_scc1 L_ld_fin1
    s_add_u32 s49, s57, 1632
    s_bfe_u32 s53, s49, 0x30008
    s_lshl_b32 s53, s53, 22
    s_and_b32 s54, s49, 0xff
    s_lshl_b32 s54, s54, 13
    s_add_u32 s53, s53, s54
    s_bfe_u32 s54, s49, 65540
    s_lshl_b32 s54, s54, 21
    s_add_u32 s53, s53, s54
    s_add_u32 s48, s53, s55
    s_xor_b32 s47, s48, 0x200000
    s_cmp_lt_u32 s50, s51
    s_cbranch_scc1 L_ld_go_g0
L_ld_spin_g0:
    ds_read_b96 v[20:22], v3
    s_waitcnt lgkmcnt(0)
    v_min3_u32 v20, v20, v21, v22
    s_nop 0
    v_readfirstlane_b32 s51, v20
    s_add_u32 s51, s51, 9
    s_cmp_lt_u32 s50, s51
    s_cbranch_scc1 L_ld_go_g0
    s_sleep 1
    s_sub_u32 s96, s96, 1
    s_cmp_gt_i32 s96, 0
    s_cbranch_scc1 L_ld_spin_g0
L_ld_go_g0:
    s_lshl_b32 s57, s57, 7
    s_add_u32 s57, s57, s56
    s_lshr_b32 s58, s52, 7
    s_add_u32 m0, s58, 147456
    s_mov_b64 exec, 1
    global_atomic_add v40, v42, v44, s[28:29] sc0 sc1
    s_mov_b64 exec, s[62:63]
    buffer_load_dword v45, s[40:43], s57 offen sc1 lds
    s_mov_b64 exec, -1
    s_add_u32 m0, s52, 0
    s_add_u32 s54, s48, 0
    buffer_load_dwordx4 v16, s[36:39], s54 offen offset:0 nt lds
    buffer_load_dwordx4 v17, s[36:39], s54 offen offset:1024 nt lds
    buffer_load_dwordx4 v18, s[36:39], s54 offen offset:2048 nt lds
    buffer_load_dwordx4 v19, s[36:39], s54 offen offset:3072 nt lds
    s_add_u32 m0, s52, 4096
    s_add_u32 s54, s48, 4096
    buffer_load_dwordx4 v16, s[36:39], s54 offen offset:0 nt lds
    buffer_load_dwordx4 v17, s[36:39], s54 offen offset:1024 nt lds
    buffer_load_dwordx4 v18, s[36:39], s54 offen offset:2048 nt lds
    buffer_load_dwordx4 v19, s[36:39], s54 offen offset:3072 nt lds
    s_add_u32 m0, s52, 8192
    s_add_u32 s54, s47, 0
    buffer_load_dwordx4 v16, s[36:39], s54 offen offset:0 nt lds
    ds_read_b96 v[20:22], v3
    buffer_load_dwordx4 v17, s[36:39], s54 offen offset:1024 nt lds
    buffer_load_dwordx4 v18, s[36:39], s54 offen offset:2048 nt lds
    buffer_load_dwordx4 v19, s[36:39], s54 offen offset:3072 nt lds
    s_add_u32 m0, s52, 12288
    s_add_u32 s54, s47, 4096
    buffer_load_dwordx4 v16, s[36:39], s54 offen offset:0 nt lds
    buffer_load_dwordx4 v17, s[36:39], s54 offen offset:1024 nt lds
    s_waitcnt lgkmcnt(0)
    v_min3_u32 v20, v20, v21, v22
    buffer_load_dwordx4 v18, s[36:39], s54 offen offset:2048 nt lds
    v_readfirstlane_b32 s51, v20
    s_add_u32 s51, s51, 9
    buffer_load_dwordx4 v19, s[36:39], s54 offen offset:3072 nt lds
    s_add_u32 s50, s50, 1
    s_add_u32 s52, s52, 16384
    s_cmp_eq_u32 s52, 147456
    s_cselect_b32 s52, 0, s52
    s_waitcnt vmcnt(44)
    s_lshl_b32 s53, s50, 1
    s_add_i32 s53, s53, -5
    v_max_i32 v4, s53, v4
    ds_write_b32 v2, v4
    s_waitcnt vmcnt(36)
    s_lshl_b32 s53, s50, 1
    s_add_i32 s53, s53, -4
    v_max_i32 v4, s53, v4
    ds_write_b32 v2, v4
    s_waitcnt vmcnt(35)
    v_readfirstlane_b32 s58, v41
    s_and_b32 s57, s58, 15
    s_andn2_b32 s49, s58, 15
    s_lshl_b32 s49, s49, 1
    s_add_u32 s57, s57, s49
    s_add_u32 s57, s57, s65
    s_add_u32 s57, s57, 16
L_ld_gin1:
    s_cmp_ge_u32 s57, 416
    s_cbranch_scc1 L_ld_fin0
    s_add_u32 s49, s57, 1632
    s_bfe_u32 s53, s49, 0x30008
    s_lshl_b32 s53, s53, 22
    s_and_b32 s54, s49, 0xff
    s_lshl_b32 s54, s54, 13
    s_add_u32 s53, s53, s54
    s_bfe_u32 s54, s49, 65540
    s_lshl_b32 s54, s54, 21
    s_add_u32 s53, s53, s54
    s_add_u32 s48, s53, s55
    s_xor_b32 s47, s48, 0x200000
    s_cmp_lt_u32 s50, s51
    s_cbranch_scc1 L_ld_go_g1
L_ld_spin_g1:
    ds_read_b96 v[20:22], v3
    s_waitcnt lgkmcnt(0)
    v_min3_u32 v20, v20, v21, v22
    s_nop 0
    v_readfirstlane_b32 s51, v20
    s_add_u32 s51, s51, 9
    s_cmp_lt_u32 s50, s51
    s_cbranch_scc1 L_ld_go_g1
    s_sleep 1
    s_sub_u32 s96, s96, 1
    s_cmp_gt_i32 s96, 0
    s_cbranch_scc1 L_ld_spin_g1
L_ld_go_g1:
    s_lshl_b32 s57, s57, 7
    s_add_u32 s57, s57, s56
    s_lshr_b32 s58, s52, 7
    s_add_u32 m0, s58, 147456
    s_mov_b64 exec, 1
    global_atomic_add v41, v43, v44, s[28:29] sc0 sc1
    s_mov_b64 exec, s[62:63]
    buffer_load_dword v45, s[40:43], s57 offen sc1 lds
    s_mov_b64 exec, -1
    s_add_u32 m0, s52, 0
    s_add_u32 s54, s48, 0
    buffer_load_dwordx4 v16, s[36:39], s54 offen offset:0 nt lds
    buffer_load_dwordx4 v17, s[36:39], s54 offen offset:1024 nt lds
    buffer_load_dwordx4 v18, s[36:39], s54 offen offset:2048 nt lds
    buffer_load_dwordx4 v19, s[36:39], s54 offen offset:3072 nt lds
    s_add_u32 m0, s52, 4096
    s_add_u32 s54, s48, 4096
    buffer_load_dwordx4 v16, s[36:39], s54 offen offset:0 nt lds
    buffer_load_dwordx4 v17, s[36:39], s54 offen offset:1024 nt lds
    buffer_load_dwordx4 v18, s[36:39], s54 offen offset:2048 nt lds
    buffer_load_dwordx4 v19, s[36:39], s54 offen offset:3072 nt lds
    s_add_u32 m0, s52, 8192
    s_add_u32 s54, s47, 0
    buffer_load_dwordx4 v16, s[36:39], s54 offen offset:0 nt lds
    ds_read_b96 v[20:22], v3
    buffer_load_dwordx4 v17, s[36:39], s54 offen offset:1024 nt lds
    buffer_load_dwordx4 v18, s[36:39], s54 offen offset:2048 nt lds
    buffer_load_dwordx4 v19, s[36:39], s54 offen offset:3072 nt lds
    s_add_u32 m0, s52, 12288
    s_add_u32 s54, s47, 4096
    buffer_load_dwordx4 v16, s[36:39], s54 offen offset:0 nt lds
    buffer_load_dwordx4 v17, s[36:39], s54 offen offset:1024 nt lds
    s_waitcnt lgkmcnt(0)
    v_min3_u32 v20, v20, v21, v22
    buffer_load_dwordx4 v18, s[36:39], s54 offen offset:2048 nt lds
    v_readfirstlane_b32 s51, v20
    s_add_u32 s51, s51, 9
    buffer_load_dwordx4 v19, s[36:39], s54 offen offset:3072 nt lds
    s_add_u32 s50, s50, 1
    s_add_u32 s52, s52, 16384
    s_cmp_eq_u32 s52, 147456
    s_cselect_b32 s52, 0, s52
    s_branch L_ld_greedy
L_ld_fin0:
    ds_write_b32 v3, v3 offset:36
    s_waitcnt vmcnt(26)
    s_lshl_b32 s53, s50, 1
    s_add_i32 s53, s53, -3
    v_max_i32 v4, s53, v4
    ds_write_b32 v2, v4
    s_waitcnt vmcnt(18)
    s_lshl_b32 s53, s50, 1
    s_add_i32 s53, s53, -2
    v_max_i32 v4, s53, v4
    ds_write_b32 v2, v4
    s_waitcnt vmcnt(17)
    v_readfirstlane_b32 s58, v40
    s_and_b32 s57, s58, 15
    s_andn2_b32 s49, s58, 15
    s_lshl_b32 s49, s49, 1
    s_add_u32 s57, s57, s49
    s_add_u32 s57, s57, s65
    s_cmp_ge_u32 s57, 416
    s_cbranch_scc1 L_ld_end
    s_add_u32 s49, s57, 1632
    s_bfe_u32 s53, s49, 0x30008
    s_lshl_b32 s53, s53, 22
    s_and_b32 s54, s49, 0xff
    s_lshl_b32 s54, s54, 13
    s_add_u32 s53, s53, s54
    s_bfe_u32 s54, s49, 65540
    s_lshl_b32 s54, s54, 21
    s_add_u32 s53, s53, s54
    s_add_u32 s48, s53, s55
    s_xor_b32 s47, s48, 0x200000
    s_cmp_lt_u32 s50, s51
    s_cbranch_scc1 L_ld_go_f0
L_ld_spin_f0:
    ds_read_b96 v[20:22], v3
    s_waitcnt lgkmcnt(0)
    v_min3_u32 v20, v20, v21, v22
    s_nop 0
    v_readfirstlane_b32 s51, v20
    s_add_u32 s51, s51, 9
    s_cmp_lt_u32 s50, s51
    s_cbranch_scc1 L_ld_go_f0
    s_sleep 1
    s_sub_u32 s96, s96, 1
    s_cmp_gt_i32 s96, 0
    s_cbranch_scc1 L_ld_spin_f0
L_ld_go_f0:
    s_lshl_b32 s57, s57, 7
    s_add_u32 s57, s57, s56
    s_lshr_b32 s58, s52, 7
    s_add_u32 m0, s58, 147456
    s_mov_b64 exec, 1
    global_atomic_add v40, v42, v44, s[28:29] sc0 sc1
    s_mov_b64 exec, s[62:63]
    buffer_load_dword v45, s[40:43], s57 offen sc1 lds
    s_mov_b64 exec, -1
    s_add_u32 m0, s52, 0
    s_add_u32 s54, s48, 0
    buffer_load_dwordx4 v16, s[36:39], s54 offen offset:0 nt lds
    buffer_load_dwordx4 v17, s[36:39], s54 offen offset:1024 nt lds
    buffer_load_dwordx4 v18, s[36:39], s54 offen offset:2048 nt lds
    buffer_load_dwordx4 v19, s[36:39], s54 offen offset:3072 nt lds
    s_add_u32 m0, s52, 4096
    s_add_u32 s54, s48, 4096
    buffer_load_dwordx4 v16, s[36:39], s54 offen offset:0 nt lds
    buffer_load_dwordx4 v17, s[36:39], s54 offen offset:1024 nt lds
    buffer_load_dwordx4 v18, s[36:39], s54 offen offset:2048 nt lds
    buffer_load_dwordx4 v19, s[36:39], s54 offen offset:3072 nt lds
    s_add_u32 m0, s52, 8192
    s_add_u32 s54, s47, 0
    buffer_load_dwordx4 v16, s[36:39], s54 offen offset:0 nt lds
    ds_read_b96 v[20:22], v3
    buffer_load_dwordx4 v17, s[36:39], s54 offen offset:1024 nt lds
    buffer_load_dwordx4 v18, s[36:39], s54 offen offset:2048 nt lds
    buffer_load_dwordx4 v19, s[36:39], s54 offen offset:3072 nt lds
    s_add_u32 m0, s52, 12288
    s_add_u32 s54, s47, 4096
    buffer_load_dwordx4 v16, s[36:39], s54 offen offset:0 nt lds
    buffer_load_dwordx4 v17, s[36:39], s54 offen offset:1024 nt lds
    s_waitcnt lgkmcnt(0)
    v_min3_u32 v20, v20, v21, v22
    buffer_load_dwordx4 v18, s[36:39], s54 offen offset:2048 nt lds
    v_readfirstlane_b32 s51, v20
    s_add_u32 s51, s51, 9
    buffer_load_dwordx4 v19, s[36:39], s54 offen offset:3072 nt lds
    s_add_u32 s50, s50, 1
    s_add_u32 s52, s52, 16384
    s_cmp_eq_u32 s52, 147456
    s_cselect_b32 s52, 0, s52
    s_branch L_ld_fin0
L_ld_fin1:
    ds_write_b32 v3, v3 offset:36
    s_waitcnt vmcnt(26)
    s_lshl_b32 s53, s50, 1
    s_add_i32 s53, s53, -3
    v_max_i32 v4, s53, v4
    ds_write_b32 v2, v4
    s_waitcnt vmcnt(18)
    s_lshl_b32 s53, s50, 1
    s_add_i32 s53, s53, -2
    v_max_i32 v4, s53, v4
    ds_write_b32 v2, v4
    s_waitcnt vmcnt(17)
    v_readfirstlane_b32 s58, v41
    s_and_b32 s57, s58, 15
    s_andn2_b32 s49, s58, 15
    s_lshl_b32 s49, s49, 1
    s_add_u32 s57, s57, s49
    s_add_u32 s57, s57, s65
    s_add_u32 s57, s57, 16
    s_cmp_ge_u32 s57, 416
    s_cbranch_scc1 L_ld_end
    s_add_u32 s49, s57, 1632
    s_bfe_u32 s53, s49, 0x30008
    s_lshl_b32 s53, s53, 22
    s_and_b32 s54, s49, 0xff
    s_lshl_b32 s54, s54, 13
    s_add_u32 s53, s53, s54
    s_bfe_u32 s54, s49, 65540
    s_lshl_b32 s54, s54, 21
    s_add_u32 s53, s53, s54
    s_add_u32 s48, s53, s55
    s_xor_b32 s47, s48, 0x200000
    s_cmp_lt_u32 s50, s51
    s_cbranch_scc1 L_ld_go_f1
L_ld_spin_f1:
    ds_read_b96 v[20:22], v3
    s_waitcnt lgkmcnt(0)
    v_min3_u32 v20, v20, v21, v22
    s_nop 0
    v_readfirstlane_b32 s51, v20
    s_add_u32 s51, s51, 9
    s_cmp_lt_u32 s50, s51
    s_cbranch_scc1 L_ld_go_f1
    s_sleep 1
    s_sub_u32 s96, s96, 1
    s_cmp_gt_i32 s96, 0
    s_cbranch_scc1 L_ld_spin_f1
L_ld_go_f1:
    s_lshl_b32 s57, s57, 7
    s_add_u32 s57, s57, s56
    s_lshr_b32 s58, s52, 7
    s_add_u32 m0, s58, 147456
    s_mov_b64 exec, 1
    global_atomic_add v41, v43, v44, s[28:29] sc0 sc1
    s_mov_b64 exec, s[62:63]
    buffer_load_dword v45, s[40:43], s57 offen sc1 lds
    s_mov_b64 exec, -1
    s_add_u32 m0, s52, 0
    s_add_u32 s54, s48, 0
    buffer_load_dwordx4 v16, s[36:39], s54 offen offset:0 nt lds
    buffer_load_dwordx4 v17, s[36:39], s54 offen offset:1024 nt lds
    buffer_load_dwordx4 v18, s[36:39], s54 offen offset:2048 nt lds
    buffer_load_dwordx4 v19, s[36:39], s54 offen offset:3072 nt lds
    s_add_u32 m0, s52, 4096
    s_add_u32 s54, s48, 4096
    buffer_load_dwordx4 v16, s[36:39], s54 offen offset:0 nt lds
    buffer_load_dwordx4 v17, s[36:39], s54 offen offset:1024 nt lds
    buffer_load_dwordx4 v18, s[36:39], s54 offen offset:2048 nt lds
    buffer_load_dwordx4 v19, s[36:39], s54 offen offset:3072 nt lds
    s_add_u32 m0, s52, 8192
    s_add_u32 s54, s47, 0
    buffer_load_dwordx4 v16, s[36:39], s54 offen offset:0 nt lds
    ds_read_b96 v[20:22], v3
    buffer_load_dwordx4 v17, s[36:39], s54 offen offset:1024 nt lds
    buffer_load_dwordx4 v18, s[36:39], s54 offen offset:2048 nt lds
    buffer_load_dwordx4 v19, s[36:39], s54 offen offset:3072 nt lds
    s_add_u32 m0, s52, 12288
    s_add_u32 s54, s47, 4096
    buffer_load_dwordx4 v16, s[36:39], s54 offen offset:0 nt lds
    buffer_load_dwordx4 v17, s[36:39], s54 offen offset:1024 nt lds
    s_waitcnt lgkmcnt(0)
    v_min3_u32 v20, v20, v21, v22
    buffer_load_dwordx4 v18, s[36:39], s54 offen offset:2048 nt lds
    v_readfirstlane_b32 s51, v20
    s_add_u32 s51, s51, 9
    buffer_load_dwordx4 v19, s[36:39], s54 offen offset:3072 nt lds
    s_add_u32 s50, s50, 1
    s_add_u32 s52, s52, 16384
    s_cmp_eq_u32 s52, 147456
    s_cselect_b32 s52, 0, s52
    s_branch L_ld_fin1
L_ld_end:
    v_mov_b32 v5, s50
    ds_write_b32 v2, v5 offset:4
    s_waitcnt vmcnt(8)
    s_lshl_b32 s53, s50, 1
    s_add_i32 s53, s53, -1
    v_max_i32 v4, s53, v4
    ds_write_b32 v2, v4
    s_waitcnt vmcnt(0)
    s_lshl_b32 s53, s50, 1
    s_add_i32 s53, s53, 0
    v_max_i32 v4, s53, v4
    ds_write_b32 v2, v4
    s_endpgm
L_master:
    s_setprio 3
    s_and_b32 s50, s2, 3
    s_lshr_b32 s51, s2, 2
    s_mul_i32 s49, s50, 917504
    s_lshl_b32 s52, s51, 7
    s_add_u32 s49, s49, s52
    s_lshl_b32 s48, s50, 15
    s_lshl_b32 s52, s51, 9
    s_add_u32 s48, s48, s52
    v_lshrrev_b32 v1, 3, v0
    v_mul_u32_u24 v1, 8192, v1
    v_bfe_u32 v2, v0, 4, 2
    v_lshlrev_b32 v2, 1, v2
    v_and_b32 v3, 7, v0
    v_xor_b32 v2, v2, v3
    v_lshl_add_u32 v1, v2, 4, v1
    s_mul_i32 s50, s50, 224
    v_lshrrev_b32 v2, 4, v0
    v_lshl_add_u32 v2, v2, 3, s50
    s_waitcnt lgkmcnt(0)
    s_mov_b32 s40, s10
    s_and_b32 s41, s11, 0xffff
    s_mov_b32 s42, 0x380000
    s_mov_b32 s43, 0x20000
    s_mov_b32 m0, 147456
    s_nop 0
    buffer_load_dwordx4 v1, s[40:43], s49 offen nt lds
    s_mov_b32 m0, 148480
    s_add_u32 s49, s49, 65536
    buffer_load_dwordx4 v1, s[40:43], s49 offen nt lds
    s_mov_b32 m0, 149504
    s_add_u32 s49, s49, 65536
    buffer_load_dwordx4 v1, s[40:43], s49 offen nt lds
    s_mov_b32 m0, 150528
    s_add_u32 s49, s49, 65536
    buffer_load_dwordx4 v1, s[40:43], s49 offen nt lds
    s_mov_b32 m0, 151552
    s_add_u32 s49, s49, 65536
    buffer_load_dwordx4 v1, s[40:43], s49 offen nt lds
    s_mov_b32 m0, 152576
    s_add_u32 s49, s49, 65536
    buffer_load_dwordx4 v1, s[40:43], s49 offen nt lds
    s_mov_b32 m0, 153600
    s_add_u32 s49, s49, 65536
    buffer_load_dwordx4 v1, s[40:43], s49 offen nt lds
    s_mov_b32 m0, 154624
    s_add_u32 s49, s49, 65536
    buffer_load_dwordx4 v1, s[40:43], s49 offen nt lds
    s_mov_b32 m0, 155648
    s_add_u32 s49, s49, 65536
    buffer_load_dwordx4 v1, s[40:43], s49 offen nt lds
    s_mov_b32 m0, 156672
    s_add_u32 s49, s49, 65536
    buffer_load_dwordx4 v1, s[40:43], s49 offen nt lds
    s_mov_b32 m0, 157696
    s_add_u32 s49, s49, 65536
    buffer_load_dwordx4 v1, s[40:43], s49 offen nt lds
    s_mov_b32 m0, 158720
    s_add_u32 s49, s49, 65536
    buffer_load_dwordx4 v1, s[40:43], s49 offen nt lds
    s_mov_b32 m0, 159744
    s_add_u32 s49, s49, 65536
    buffer_load_dwordx4 v1, s[40:43], s49 offen nt lds
    s_mov_b32 m0, 160768
    s_add_u32 s49, s49, 65536
    buffer_load_dwordx4 v1, s[40:43], s49 offen nt lds
    s_barrier
    global_load_dwordx2 v[64:65], v2, s[4:5] offset:0
    global_load_dwordx2 v[66:67], v2, s[4:5] offset:32
    global_load_dwordx2 v[68:69], v2, s[4:5] offset:64
    global_load_dwordx2 v[70:71], v2, s[4:5] offset:96
    global_load_dwordx2 v[72:73], v2, s[4:5] offset:128
    global_load_dwordx2 v[74:75], v2, s[4:5] offset:160
    global_load_dwordx2 v[76:77], v2, s[4:5] offset:192
    s_cmp_eq_u32 s3, 0
    s_cbranch_scc0 L_m_noclr
    s_mul_i32 s52, s31, 16384
    s_add_u32 s52, s52, 262144
    v_mul_u32_u24 v4, 4096, v0
    v_add_u32 v4, s52, v4
    v_mov_b32 v5, 0
    s_mov_b64 exec, 7
    global_store_dword v4, v5, s[28:29] sc1
    s_mov_b64 exec, -1
L_m_noclr:
    s_setprio 0
    s_mul_i32 s52, s2, 896
    s_add_u32 s52, s52, 1572864
    v_lshl_add_u32 v4, v0, 4, s52
    v_mov_b32 v20, -1
    v_mov_b32 v21, -1
    v_mov_b32 v22, -1
    v_mov_b32 v23, -1
    s_mov_b32 s52, -1
    s_mov_b32 s53, 0xffffff
    s_mov_b64 exec, s[52:53]
    global_store_dwordx4 v4, v[20:23], s[28:29] sc1
    s_mov_b64 exec, -1
    s_lshl_b32 s52, s2, 11
    s_add_u32 s52, s52, 1048576
    v_lshl_add_u32 v4, v0, 4, s52
    v_mov_b32 v23, 0
    s_nop 1
    global_store_dwordx4 v4, v[20:23], s[28:29] sc1
    global_store_dwordx4 v4, v[20:23], s[28:29] offset:1024 sc1
    v_lshrrev_b32 v3, 2, v0
    v_lshlrev_b32 v6, 7, v3
    v_and_b32 v7, 3, v0
    v_lshl_add_u32 v6, v7, 3, v6
    v_add_u32 v6, 147456, v6
    v_bfe_u32 v3, v0, 3, 2
    v_xor_b32 v7, 0, v3
    v_lshl_add_u32 v8, v7, 5, v6
    v_xor_b32 v7, 1, v3
    v_lshl_add_u32 v9, v7, 5, v6
    v_xor_b32 v7, 2, v3
    v_lshl_add_u32 v10, v7, 5, v6
    v_xor_b32 v7, 3, v3
    v_lshl_add_u32 v11, v7, 5, v6
    v_lshl_add_u32 v12, v0, 3, s48
    v_cmp_lt_u32 s[70:71], 15, v0
    v_cmp_lt_u32 s[72:73], 31, v0
    v_cmp_lt_u32 s[74:75], 47, v0
    s_waitcnt vmcnt(0)
    ds_read_b64_tr_b16 v[128:129], v8 offset:0
    ds_read_b64_tr_b16 v[130:131], v8 offset:2048
    ds_read_b64_tr_b16 v[132:133], v8 offset:4096
    ds_read_b64_tr_b16 v[134:135], v8 offset:6144
    ds_read_b64_tr_b16 v[136:137], v8 offset:8192
    ds_read_b64_tr_b16 v[138:139], v8 offset:10240
    ds_read_b64_tr_b16 v[140:141], v8 offset:12288
    ds_read_b64_tr_b16 v[144:145], v9 offset:0
    ds_read_b64_tr_b16 v[146:147], v9 offset:2048
    ds_read_b64_tr_b16 v[148:149], v9 offset:4096
    ds_read_b64_tr_b16 v[150:151], v9 offset:6144
    ds_read_b64_tr_b16 v[152:153], v9 offset:8192
    ds_read_b64_tr_b16 v[154:155], v9 offset:10240
    ds_read_b64_tr_b16 v[156:157], v9 offset:12288
    s_waitcnt lgkmcnt(0)
    ds_read_b64_tr_b16 v[160:161], v10 offset:0
    ds_read_b64_tr_b16 v[162:163], v10 offset:2048
    ds_read_b64_tr_b16 v[164:165], v10 offset:4096
    ds_read_b64_tr_b16 v[166:167], v10 offset:6144
    ds_read_b64_tr_b16 v[168:169], v10 offset:8192
    ds_read_b64_tr_b16 v[170:171], v10 offset:10240
    ds_read_b64_tr_b16 v[172:173], v10 offset:12288
    ds_read_b64_tr_b16 v[176:177], v11 offset:0
    ds_read_b64_tr_b16 v[178:179], v11 offset:2048
    ds_read_b64_tr_b16 v[180:181], v11 offset:4096
    ds_read_b64_tr_b16 v[182:183], v11 offset:6144
    ds_read_b64_tr_b16 v[184:185], v11 offset:8192
    ds_read_b64_tr_b16 v[186:187], v11 offset:10240
    ds_read_b64_tr_b16 v[188:189], v11 offset:12288
    v_mfma_f32_16x16x32_bf16 v[192:195], v[64:67], v[128:131], 0
    v_mfma_f32_16x16x32_bf16 v[192:195], v[68:71], v[132:135], v[192:195]
    v_mfma_f32_16x16x32_bf16 v[192:195], v[72:75], v[136:139], v[192:195]
    v_mfma_f32_16x16x32_bf16 v[196:199], v[64:67], v[144:147], 0
    v_mfma_f32_16x16x32_bf16 v[196:199], v[68:71], v[148:151], v[196:199]
    v_mfma_f32_16x16x32_bf16 v[196:199], v[72:75], v[152:155], v[196:199]
    s_waitcnt lgkmcnt(0)
    v_mfma_f32_16x16x32_bf16 v[200:203], v[64:67], v[160:163], 0
    v_mfma_f32_16x16x32_bf16 v[200:203], v[68:71], v[164:167], v[200:203]
    v_mfma_f32_16x16x32_bf16 v[200:203], v[72:75], v[168:171], v[200:203]
    v_mfma_f32_16x16x32_bf16 v[204:207], v[64:67], v[176:179], 0
    v_mfma_f32_16x16x32_bf16 v[204:207], v[68:71], v[180:183], v[204:207]
    v_mfma_f32_16x16x32_bf16 v[204:207], v[72:75], v[184:187], v[204:207]
    s_nop 3
    v_mfma_f32_16x16x16_bf16 v[192:195], v[76:77], v[140:141], v[192:195]
    v_mfma_f32_16x16x16_bf16 v[196:199], v[76:77], v[156:157], v[196:199]
    v_mfma_f32_16x16x16_bf16 v[200:203], v[76:77], v[172:173], v[200:203]
    v_mfma_f32_16x16x16_bf16 v[204:207], v[76:77], v[188:189], v[204:207]
    s_nop 7
    s_nop 1
    v_cndmask_b32 v16, v192, v196, s[70:71]
    v_cndmask_b32 v16, v16, v200, s[72:73]
    v_cndmask_b32 v16, v16, v204, s[74:75]
    v_mov_b32 v2, 163348
L_lw_mn:
    ds_read_b32 v3, v2
    s_waitcnt lgkmcnt(0)
    v_readfirstlane_b32 s60, v3
    s_cmp_lg_u32 s60, 0
    s_cbranch_scc1 L_lwd_mn
    s_sleep 1
    s_sub_u32 s96, s96, 1
    s_cmp_gt_i32 s96, 0
    s_cbranch_scc1 L_lw_mn
L_lwd_mn:
    s_not_b32 s61, s60
    v_and_b32 v14, 1, v0
    v_cmp_eq_u32 vcc, 1, v14
    v_mov_b32 v14, s60
    v_mov_b32 v15, s61
    v_cndmask_b32 v17, v14, v15, vcc
    global_store_dwordx2 v12, v[16:17], s[28:29] sc1
L_m_gate:
    v_mov_b32 v2, 163340
    v_mov_b32 v3, 1
    s_mov_b64 exec, 1
    ds_add_u32 v2, v3
    s_mov_b64 exec, -1
    s_mov_b32 s40, s4
    s_and_b32 s41, s5, 0xffff
    s_mov_b32 s42, 0x380
    s_mov_b32 s43, 0x20000
    s_mov_b32 s44, s22
    s_and_b32 s45, s23, 0xffff
    s_mov_b32 s46, 0x380
    s_mov_b32 s47, 0x20000
    v_lshlrev_b32 v1, 4, v0
    buffer_load_dwordx4 v[8:11], v1, s[40:43], 0 offen
    buffer_load_dwordx4 v[12:15], v1, s[44:47], 0 offen
    s_mov_b32 s57, 0xffff0000
    s_mov_b32 s54, 0xbfb8aa3b
    s_waitcnt vmcnt(0)
    v_lshlrev_b32 v16, 16, v8
    v_and_b32 v17, s57, v8
    v_lshlrev_b32 v18, 16, v12
    v_and_b32 v19, s57, v12
    v_mul_f32 v16, v16, v18
    v_mul_f32 v17, v17, v19
    v_cvt_pk_bf16_f32 v16, v16, v17
    v_and_b32 v17, s57, v16
    v_lshlrev_b32 v16, 16, v16
    v_add_f32 v20, v16, v17
    v_lshlrev_b32 v16, 16, v9
    v_and_b32 v17, s57, v9
    v_lshlrev_b32 v18, 16, v13
    v_and_b32 v19, s57, v13
    v_mul_f32 v16, v16, v18
    v_mul_f32 v17, v17, v19
    v_cvt_pk_bf16_f32 v16, v16, v17
    v_and_b32 v17, s57, v16
    v_lshlrev_b32 v16, 16, v16
    v_add_f32 v20, v20, v16
    v_add_f32 v20, v20, v17
    v_lshlrev_b32 v16, 16, v10
    v_and_b32 v17, s57, v10
    v_lshlrev_b32 v18, 16, v14
    v_and_b32 v19, s57, v14
    v_mul_f32 v16, v16, v18
    v_mul_f32 v17, v17, v19
    v_cvt_pk_bf16_f32 v16, v16, v17
    v_and_b32 v17, s57, v16
    v_lshlrev_b32 v16, 16, v16
    v_add_f32 v20, v20, v16
    v_add_f32 v20, v20, v17
    v_lshlrev_b32 v16, 16, v11
    v_and_b32 v17, s57, v11
    v_lshlrev_b32 v18, 16, v15
    v_and_b32 v19, s57, v15
    v_mul_f32 v16, v16, v18
    v_mul_f32 v17, v17, v19
    v_cvt_pk_bf16_f32 v16, v16, v17
    v_and_b32 v17, s57, v16
    v_lshlrev_b32 v16, 16, v16
    v_add_f32 v20, v20, v16
    v_add_f32 v20, v20, v17
    s_nop 1
    v_add_f32_dpp v20, v20, v20 row_ror:8 row_mask:0xf bank_mask:0xf
    s_nop 1
    v_add_f32_dpp v20, v20, v20 row_ror:4 row_mask:0xf bank_mask:0xf
    s_nop 1
    v_add_f32_dpp v20, v20, v20 row_ror:2 row_mask:0xf bank_mask:0xf
    s_nop 1
    v_add_f32_dpp v20, v20, v20 row_ror:1 row_mask:0xf bank_mask:0xf
    v_mov_b32 v21, v20
    s_nop 1
    v_permlane16_swap_b32 v20, v21
    v_add_f32 v20, v20, v21
    v_mov_b32 v21, v20
    s_nop 1
    v_permlane32_swap_b32 v20, v21
    v_add_f32 v20, v20, v21
    v_cvt_pk_bf16_f32 v20, v20, v20
    v_lshlrev_b32 v20, 16, v20
    v_mul_f32 v20, s54, v20
    v_exp_f32 v20, v20
    s_nop 0
    v_add_f32 v20, 1.0, v20
    v_rcp_f32 v20, v20
    s_nop 0
    v_cvt_pk_bf16_f32 v20, v20, v20
    v_lshlrev_b32 v20, 16, v20
    v_sub_f32 v21, 1.0, v20
    v_cvt_pk_bf16_f32 v21, v21, v21
    v_lshlrev_b32 v21, 16, v21
    s_nop 0
    v_readfirstlane_b32 s62, v20
    v_readfirstlane_b32 s63, v21
    s_mov_b32 s40, s12
    s_and_b32 s41, s13, 0xffff
    s_mov_b32 s42, 0x380000
    s_mov_b32 s43, 0x20000
    s_lshr_b32 s55, s2, 4
    s_lshl_b32 s55, s55, 8
    s_and_b32 s56, s2, 15
    s_lshl_b32 s56, s56, 2
    s_add_u32 s55, s55, s56
    s_mul_i32 s55, s55, 896
    s_mov_b32 s58, -1
    s_mov_b32 s59, 0xffffff
    s_lshl_b32 s48, s2, 11
    s_add_u32 s48, s48, 1048576
    v_add_u32 v4, s48, v1
    s_mul_i32 s48, s2, 896
    s_add_u32 s48, s48, 1572864
    v_add_u32 v6, s48, v1
    v_mov_b32 v7, 162816
L_m_wait:
    s_sleep 2
    ds_read_b64 v[2:3], v7
    s_waitcnt lgkmcnt(0)
    v_readfirstlane_b32 s48, v2
    v_readfirstlane_b32 s49, v3
    s_cmp_lt_i32 s49, 0
    s_cbranch_scc1 L_m_wait2
    s_lshl_b32 s49, s49, 1
    s_sub_u32 s49, s49, 0
    s_cmp_ge_i32 s48, s49
    s_cbranch_scc1 L_m_go
L_m_wait2:
    s_sub_u32 s96, s96, 1
    s_cmp_gt_i32 s96, 0
    s_cbranch_scc1 L_m_wait
L_m_go:
    s_mov_b64 exec, s[58:59]
    buffer_load_dwordx4 v[192:195], v1, s[40:43], s55 offen offset:0 nt
    buffer_load_dwordx4 v[196:199], v1, s[40:43], s55 offen offset:896 nt
    buffer_load_dwordx4 v[200:203], v1, s[40:43], s55 offen offset:1792 nt
    buffer_load_dwordx4 v[204:207], v1, s[40:43], s55 offen offset:2688 nt
    s_add_u32 s55, s55, 57344
    buffer_load_dwordx4 v[208:211], v1, s[40:43], s55 offen offset:0 nt
    buffer_load_dwordx4 v[212:215], v1, s[40:43], s55 offen offset:896 nt
    buffer_load_dwordx4 v[216:219], v1, s[40:43], s55 offen offset:1792 nt
    buffer_load_dwordx4 v[220:223], v1, s[40:43], s55 offen offset:2688 nt
    s_add_u32 s55, s55, 57344
    buffer_load_dwordx4 v[224:227], v1, s[40:43], s55 offen offset:0 nt
    buffer_load_dwordx4 v[228:231], v1, s[40:43], s55 offen offset:896 nt
    buffer_load_dwordx4 v[232:235], v1, s[40:43], s55 offen offset:1792 nt
    buffer_load_dwordx4 v[236:239], v1, s[40:43], s55 offen offset:2688 nt
    s_add_u32 s55, s55, 57344
    buffer_load_dwordx4 v[240:243], v1, s[40:43], s55 offen offset:0 nt
    buffer_load_dwordx4 v[244:247], v1, s[40:43], s55 offen offset:896 nt
    buffer_load_dwordx4 v[248:251], v1, s[40:43], s55 offen offset:1792 nt
    buffer_load_dwordx4 v[252:255], v1, s[40:43], s55 offen offset:2688 nt
    s_mov_b64 exec, -1
    s_waitcnt vmcnt(15)
    v_lshlrev_b32 v64, 16, v192
    v_and_b32 v65, s57, v192
    v_lshlrev_b32 v66, 16, v193
    v_and_b32 v67, s57, v193
    v_lshlrev_b32 v68, 16, v194
    v_and_b32 v69, s57, v194
    v_lshlrev_b32 v70, 16, v195
    v_and_b32 v71, s57, v195
    s_waitcnt vmcnt(14)
    v_lshlrev_b32 v72, 16, v196
    v_and_b32 v73, s57, v196
    v_lshlrev_b32 v74, 16, v197
    v_and_b32 v75, s57, v197
    v_lshlrev_b32 v76, 16, v198
    v_and_b32 v77, s57, v198
    v_lshlrev_b32 v78, 16, v199
    v_and_b32 v79, s57, v199
    s_waitcnt vmcnt(13)
    v_lshlrev_b32 v80, 16, v200
    v_and_b32 v81, s57, v200
    v_lshlrev_b32 v82, 16, v201
    v_and_b32 v83, s57, v201
    v_lshlrev_b32 v84, 16, v202
    v_and_b32 v85, s57, v202
    v_lshlrev_b32 v86, 16, v203
    v_and_b32 v87, s57, v203
    s_waitcnt vmcnt(12)
    v_lshlrev_b32 v88, 16, v204
    v_and_b32 v89, s57, v204
    v_lshlrev_b32 v90, 16, v205
    v_and_b32 v91, s57, v205
    v_lshlrev_b32 v92, 16, v206
    v_and_b32 v93, s57, v206
    v_lshlrev_b32 v94, 16, v207
    v_and_b32 v95, s57, v207
    s_waitcnt vmcnt(11)
    v_lshlrev_b32 v96, 16, v208
    v_and_b32 v97, s57, v208
    v_lshlrev_b32 v98, 16, v209
    v_and_b32 v99, s57, v209
    v_lshlrev_b32 v100, 16, v210
    v_and_b32 v101, s57, v210
    v_lshlrev_b32 v102, 16, v211
    v_and_b32 v103, s57, v211
    s_waitcnt vmcnt(10)
    v_lshlrev_b32 v104, 16, v212
    v_and_b32 v105, s57, v212
    v_lshlrev_b32 v106, 16, v213
    v_and_b32 v107, s57, v213
    v_lshlrev_b32 v108, 16, v214
    v_and_b32 v109, s57, v214
    v_lshlrev_b32 v110, 16, v215
    v_and_b32 v111, s57, v215
    s_waitcnt vmcnt(9)
    v_lshlrev_b32 v112, 16, v216
    v_and_b32 v113, s57, v216
    v_lshlrev_b32 v114, 16, v217
    v_and_b32 v115, s57, v217
    v_lshlrev_b32 v116, 16, v218
    v_and_b32 v117, s57, v218
    v_lshlrev_b32 v118, 16, v219
    v_and_b32 v119, s57, v219
    s_waitcnt vmcnt(8)
    v_lshlrev_b32 v120, 16, v220
    v_and_b32 v121, s57, v220
    v_lshlrev_b32 v122, 16, v221
    v_and_b32 v123, s57, v221
    v_lshlrev_b32 v124, 16, v222
    v_and_b32 v125, s57, v222
    v_lshlrev_b32 v126, 16, v223
    v_and_b32 v127, s57, v223
    s_waitcnt vmcnt(7)
    v_lshlrev_b32 v128, 16, v224
    v_and_b32 v129, s57, v224
    v_lshlrev_b32 v130, 16, v225
    v_and_b32 v131, s57, v225
    v_lshlrev_b32 v132, 16, v226
    v_and_b32 v133, s57, v226
    v_lshlrev_b32 v134, 16, v227
    v_and_b32 v135, s57, v227
    s_waitcnt vmcnt(6)
    v_lshlrev_b32 v136, 16, v228
    v_and_b32 v137, s57, v228
    v_lshlrev_b32 v138, 16, v229
    v_and_b32 v139, s57, v229
    v_lshlrev_b32 v140, 16, v230
    v_and_b32 v141, s57, v230
    v_lshlrev_b32 v142, 16, v231
    v_and_b32 v143, s57, v231
    global_load_dwordx4 v[192:195], v4, s[28:29] offset:0 sc1
    global_load_dwordx4 v[196:199], v4, s[28:29] offset:1024 sc1
    s_waitcnt vmcnt(7)
    v_lshlrev_b32 v144, 16, v232
    v_and_b32 v145, s57, v232
    v_lshlrev_b32 v146, 16, v233
    v_and_b32 v147, s57, v233
    v_lshlrev_b32 v148, 16, v234
    v_and_b32 v149, s57, v234
    v_lshlrev_b32 v150, 16, v235
    v_and_b32 v151, s57, v235
    s_waitcnt vmcnt(6)
    v_lshlrev_b32 v152, 16, v236
    v_and_b32 v153, s57, v236
    v_lshlrev_b32 v154, 16, v237
    v_and_b32 v155, s57, v237
    v_lshlrev_b32 v156, 16, v238
    v_and_b32 v157, s57, v238
    v_lshlrev_b32 v158, 16, v239
    v_and_b32 v159, s57, v239
    s_waitcnt vmcnt(5)
    v_lshlrev_b32 v160, 16, v240
    v_and_b32 v161, s57, v240
    v_lshlrev_b32 v162, 16, v241
    v_and_b32 v163, s57, v241
    v_lshlrev_b32 v164, 16, v242
    v_and_b32 v165, s57, v242
    v_lshlrev_b32 v166, 16, v243
    v_and_b32 v167, s57, v243
    s_waitcnt vmcnt(4)
    v_lshlrev_b32 v168, 16, v244
    v_and_b32 v169, s57, v244
    v_lshlrev_b32 v170, 16, v245
    v_and_b32 v171, s57, v245
    v_lshlrev_b32 v172, 16, v246
    v_and_b32 v173, s57, v246
    v_lshlrev_b32 v174, 16, v247
    v_and_b32 v175, s57, v247
    s_waitcnt vmcnt(3)
    v_lshlrev_b32 v176, 16, v248
    v_and_b32 v177, s57, v248
    v_lshlrev_b32 v178, 16, v249
    v_and_b32 v179, s57, v249
    v_lshlrev_b32 v180, 16, v250
    v_and_b32 v181, s57, v250
    v_lshlrev_b32 v182, 16, v251
    v_and_b32 v183, s57, v251
    s_waitcnt vmcnt(2)
    v_lshlrev_b32 v184, 16, v252
    v_and_b32 v185, s57, v252
    v_lshlrev_b32 v186, 16, v253
    v_and_b32 v187, s57, v253
    v_lshlrev_b32 v188, 16, v254
    v_and_b32 v189, s57, v254
    v_lshlrev_b32 v190, 16, v255
    v_and_b32 v191, s57, v255
    v_add_u32 v5, 149504, v1
    s_bfe_u32 s48, s2, 0x10004
    s_lshl_b32 s48, s48, 2
    s_add_u32 s48, s48, 163384
    v_mov_b32 v13, s48
    ds_read_b32 v12, v13
    v_mov_b32 v33, s60
    v_mov_b32 v35, s61
    v_mov_b32 v37, s60
    v_mov_b32 v39, s61
    s_lshl_b32 s48, s31, 8
    s_add_u32 s48, s48, 983040
    v_mov_b32 v46, s48
    s_waitcnt lgkmcnt(0)
    s_branch L_h1_chk
L_h1_poll:
    s_mov_b64 exec, s[64:65]
    s_cbranch_execz L_h1s3
    global_load_dwordx4 v[192:195], v4, s[28:29] offset:0 sc1
L_h1s3:
    s_mov_b64 exec, s[66:67]
    s_cbranch_execz L_h1s4
    global_load_dwordx4 v[196:199], v4, s[28:29] offset:1024 sc1
L_h1s4:
    s_mov_b64 exec, -1
L_h1_chk:
    s_waitcnt vmcnt(0)
    v_max3_u32 v8, v192, v193, v194
    v_max3_u32 v9, v196, v197, v198
    v_max_u32 v8, v8, v195
    v_max_u32 v9, v9, v199
    v_cmp_eq_u32 s[64:65], -1, v8
    v_cmp_eq_u32 s[66:67], -1, v9
    s_or_b64 s[72:73], s[64:65], s[66:67]
    s_cbranch_scc0 L_h1_done
    s_sub_u32 s96, s96, 1
    s_cmp_gt_i32 s96, 0
    s_cbranch_scc1 L_h1_poll
L_h1_done:
    ds_write_b32 v7, v7 offset:540
    ds_read_b32 v47, v7 offset:544
    ds_read_b128 v[48:51], v5
    ds_read_b128 v[52:55], v5 offset:1024
    v_pk_add_f32 v[8:9], v[192:193], v[196:197]
    v_pk_add_f32 v[10:11], v[194:195], v[198:199]
    s_cmp_eq_u32 s3, 0
    s_cbranch_scc0 L_hf5
    s_mov_b64 exec, 1
    global_store_dword v46, v33, s[28:29] sc1
    s_mov_b64 exec, -1
L_hf5:
    s_nop 0
    v_permlane32_swap_b32 v8, v9
    v_permlane32_swap_b32 v10, v11
    v_add_f32 v8, v8, v9
    v_add_f32 v10, v10, v11
    s_nop 1
    v_permlane16_swap_b32 v8, v10
    v_add_f32 v8, v8, v10
    s_nop 1
    v_add_f32_dpp v8, v8, v8 row_ror:4 row_mask:0xf bank_mask:0xf
    s_nop 1
    v_add_f32_dpp v8, v8, v8 row_ror:8 row_mask:0xf bank_mask:0xf
    v_mul_f32 v8, v8, v12
    v_cvt_pk_bf16_f32 v8, v8, v8
    v_lshlrev_b32 v8, 16, v8
    v_mul_f32 v8, s62, v8
    s_nop 0
    v_readlane_b32 s64, v8, 0
    v_readlane_b32 s65, v8, 1
    v_readlane_b32 s66, v8, 2
    v_readlane_b32 s67, v8, 3
    v_readlane_b32 s68, v8, 32
    v_readlane_b32 s69, v8, 33
    v_readlane_b32 s70, v8, 34
    v_readlane_b32 s71, v8, 35
    v_readlane_b32 s72, v8, 16
    v_readlane_b32 s73, v8, 17
    v_readlane_b32 s74, v8, 18
    v_readlane_b32 s75, v8, 19
    v_readlane_b32 s76, v8, 48
    v_readlane_b32 s77, v8, 49
    v_readlane_b32 s78, v8, 50
    v_readlane_b32 s79, v8, 51
    v_pk_mul_f32 v[16:17], v[64:65], s[64:65] op_sel_hi:[1,0]
    v_pk_mul_f32 v[18:19], v[66:67], s[64:65] op_sel_hi:[1,0]
    v_pk_mul_f32 v[20:21], v[68:69], s[64:65] op_sel_hi:[1,0]
    v_pk_mul_f32 v[22:23], v[70:71], s[64:65] op_sel_hi:[1,0]
    v_pk_fma_f32 v[16:17], v[72:73], s[64:65], v[16:17] op_sel:[0,1,0] op_sel_hi:[1,1,1]
    v_pk_fma_f32 v[18:19], v[74:75], s[64:65], v[18:19] op_sel:[0,1,0] op_sel_hi:[1,1,1]
    v_pk_fma_f32 v[20:21], v[76:77], s[64:65], v[20:21] op_sel:[0,1,0] op_sel_hi:[1,1,1]
    v_pk_fma_f32 v[22:23], v[78:79], s[64:65], v[22:23] op_sel:[0,1,0] op_sel_hi:[1,1,1]
    v_pk_fma_f32 v[16:17], v[80:81], s[66:67], v[16:17] op_sel_hi:[1,0,1]
    v_pk_fma_f32 v[18:19], v[82:83], s[66:67], v[18:19] op_sel_hi:[1,0,1]
    v_pk_fma_f32 v[20:21], v[84:85], s[66:67], v[20:21] op_sel_hi:[1,0,1]
    v_pk_fma_f32 v[22:23], v[86:87], s[66:67], v[22:23] op_sel_hi:[1,0,1]
    v_pk_fma_f32 v[16:17], v[88:89], s[66:67], v[16:17] op_sel:[0,1,0] op_sel_hi:[1,1,1]
    v_pk_fma_f32 v[18:19], v[90:91], s[66:67], v[18:19] op_sel:[0,1,0] op_sel_hi:[1,1,1]
    v_pk_fma_f32 v[20:21], v[92:93], s[66:67], v[20:21] op_sel:[0,1,0] op_sel_hi:[1,1,1]
    v_pk_fma_f32 v[22:23], v[94:95], s[66:67], v[22:23] op_sel:[0,1,0] op_sel_hi:[1,1,1]
    v_pk_fma_f32 v[16:17], v[96:97], s[68:69], v[16:17] op_sel_hi:[1,0,1]
    v_pk_fma_f32 v[18:19], v[98:99], s[68:69], v[18:19] op_sel_hi:[1,0,1]
    v_pk_fma_f32 v[20:21], v[100:101], s[68:69], v[20:21] op_sel_hi:[1,0,1]
    v_pk_fma_f32 v[22:23], v[102:103], s[68:69], v[22:23] op_sel_hi:[1,0,1]
    v_pk_fma_f32 v[16:17], v[104:105], s[68:69], v[16:17] op_sel:[0,1,0] op_sel_hi:[1,1,1]
    v_pk_fma_f32 v[18:19], v[106:107], s[68:69], v[18:19] op_sel:[0,1,0] op_sel_hi:[1,1,1]
    v_pk_fma_f32 v[20:21], v[108:109], s[68:69], v[20:21] op_sel:[0,1,0] op_sel_hi:[1,1,1]
    v_pk_fma_f32 v[22:23], v[110:111], s[68:69], v[22:23] op_sel:[0,1,0] op_sel_hi:[1,1,1]
    v_pk_fma_f32 v[16:17], v[112:113], s[70:71], v[16:17] op_sel_hi:[1,0,1]
    v_pk_fma_f32 v[18:19], v[114:115], s[70:71], v[18:19] op_sel_hi:[1,0,1]
    v_pk_fma_f32 v[20:21], v[116:117], s[70:71], v[20:21] op_sel_hi:[1,0,1]
    v_pk_fma_f32 v[22:23], v[118:119], s[70:71], v[22:23] op_sel_hi:[1,0,1]
    v_pk_fma_f32 v[16:17], v[120:121], s[70:71], v[16:17] op_sel:[0,1,0] op_sel_hi:[1,1,1]
    v_pk_fma_f32 v[18:19], v[122:123], s[70:71], v[18:19] op_sel:[0,1,0] op_sel_hi:[1,1,1]
    v_pk_fma_f32 v[20:21], v[124:125], s[70:71], v[20:21] op_sel:[0,1,0] op_sel_hi:[1,1,1]
    v_pk_fma_f32 v[22:23], v[126:127], s[70:71], v[22:23] op_sel:[0,1,0] op_sel_hi:[1,1,1]
    v_pk_fma_f32 v[16:17], v[128:129], s[72:73], v[16:17] op_sel_hi:[1,0,1]
    v_pk_fma_f32 v[18:19], v[130:131], s[72:73], v[18:19] op_sel_hi:[1,0,1]
    v_pk_fma_f32 v[20:21], v[132:133], s[72:73], v[20:21] op_sel_hi:[1,0,1]
    v_pk_fma_f32 v[22:23], v[134:135], s[72:73], v[22:23] op_sel_hi:[1,0,1]
    v_pk_fma_f32 v[16:17], v[136:137], s[72:73], v[16:17] op_sel:[0,1,0] op_sel_hi:[1,1,1]
    v_pk_fma_f32 v[18:19], v[138:139], s[72:73], v[18:19] op_sel:[0,1,0] op_sel_hi:[1,1,1]
    v_pk_fma_f32 v[20:21], v[140:141], s[72:73], v[20:21] op_sel:[0,1,0] op_sel_hi:[1,1,1]
    v_pk_fma_f32 v[22:23], v[142:143], s[72:73], v[22:23] op_sel:[0,1,0] op_sel_hi:[1,1,1]
    v_pk_fma_f32 v[16:17], v[144:145], s[74:75], v[16:17] op_sel_hi:[1,0,1]
    v_pk_fma_f32 v[18:19], v[146:147], s[74:75], v[18:19] op_sel_hi:[1,0,1]
    v_pk_fma_f32 v[20:21], v[148:149], s[74:75], v[20:21] op_sel_hi:[1,0,1]
    v_pk_fma_f32 v[22:23], v[150:151], s[74:75], v[22:23] op_sel_hi:[1,0,1]
    v_pk_fma_f32 v[16:17], v[152:153], s[74:75], v[16:17] op_sel:[0,1,0] op_sel_hi:[1,1,1]
    v_pk_fma_f32 v[18:19], v[154:155], s[74:75], v[18:19] op_sel:[0,1,0] op_sel_hi:[1,1,1]
    v_pk_fma_f32 v[20:21], v[156:157], s[74:75], v[20:21] op_sel:[0,1,0] op_sel_hi:[1,1,1]
    v_pk_fma_f32 v[22:23], v[158:159], s[74:75], v[22:23] op_sel:[0,1,0] op_sel_hi:[1,1,1]
    v_pk_fma_f32 v[16:17], v[160:161], s[76:77], v[16:17] op_sel_hi:[1,0,1]
    v_pk_fma_f32 v[18:19], v[162:163], s[76:77], v[18:19] op_sel_hi:[1,0,1]
    v_pk_fma_f32 v[20:21], v[164:165], s[76:77], v[20:21] op_sel_hi:[1,0,1]
    v_pk_fma_f32 v[22:23], v[166:167], s[76:77], v[22:23] op_sel_hi:[1,0,1]
    v_pk_fma_f32 v[16:17], v[168:169], s[76:77], v[16:17] op_sel:[0,1,0] op_sel_hi:[1,1,1]
    v_pk_fma_f32 v[18:19], v[170:171], s[76:77], v[18:19] op_sel:[0,1,0] op_sel_hi:[1,1,1]
    v_pk_fma_f32 v[20:21], v[172:173], s[76:77], v[20:21] op_sel:[0,1,0] op_sel_hi:[1,1,1]
    v_pk_fma_f32 v[22:23], v[174:175], s[76:77], v[22:23] op_sel:[0,1,0] op_sel_hi:[1,1,1]
    v_pk_fma_f32 v[16:17], v[176:177], s[78:79], v[16:17] op_sel_hi:[1,0,1]
    v_pk_fma_f32 v[18:19], v[178:179], s[78:79], v[18:19] op_sel_hi:[1,0,1]
    v_pk_fma_f32 v[20:21], v[180:181], s[78:79], v[20:21] op_sel_hi:[1,0,1]
    v_pk_fma_f32 v[22:23], v[182:183], s[78:79], v[22:23] op_sel_hi:[1,0,1]
    v_pk_fma_f32 v[16:17], v[184:185], s[78:79], v[16:17] op_sel:[0,1,0] op_sel_hi:[1,1,1]
    v_pk_fma_f32 v[18:19], v[186:187], s[78:79], v[18:19] op_sel:[0,1,0] op_sel_hi:[1,1,1]
    v_pk_fma_f32 v[20:21], v[188:189], s[78:79], v[20:21] op_sel:[0,1,0] op_sel_hi:[1,1,1]
    v_pk_fma_f32 v[22:23], v[190:191], s[78:79], v[22:23] op_sel:[0,1,0] op_sel_hi:[1,1,1]
L_m_bchk:
    s_waitcnt lgkmcnt(0)
    v_readfirstlane_b32 s48, v47
    s_cmp_lg_u32 s48, 0
    s_cbranch_scc1 L_m_bok
    ds_read_b32 v47, v7 offset:544
    ds_read_b128 v[48:51], v5
    ds_read_b128 v[52:55], v5 offset:1024
    s_sub_u32 s96, s96, 1
    s_cmp_gt_i32 s96, 0
    s_cbranch_scc1 L_m_bchk
L_m_bok:
    v_pk_fma_f32 v[16:17], v[48:49], s[62:63], v[16:17] op_sel:[0,1,0] op_sel_hi:[1,1,1]
    v_pk_fma_f32 v[18:19], v[50:51], s[62:63], v[18:19] op_sel:[0,1,0] op_sel_hi:[1,1,1]
    v_pk_fma_f32 v[20:21], v[52:53], s[62:63], v[20:21] op_sel:[0,1,0] op_sel_hi:[1,1,1]
    v_pk_fma_f32 v[22:23], v[54:55], s[62:63], v[22:23] op_sel:[0,1,0] op_sel_hi:[1,1,1]
    s_mov_b64 exec, s[58:59]
    v_cvt_pk_bf16_f32 v36, v16, v17
    v_cvt_pk_bf16_f32 v37, v18, v19
    v_cvt_pk_bf16_f32 v38, v20, v21
    v_cvt_pk_bf16_f32 v39, v22, v23
    global_store_dwordx4 v6, v[36:39], s[28:29] sc1
    s_mov_b64 exec, -1
L_m_fin:
    s_endpgm
L_gather:
    v_mov_b32 v4, 0
    s_cmp_eq_u32 s2, 0
    s_cbranch_scc0 L_g_poll0
    s_memrealtime s[48:49]
    v_mov_b32 v7, 0
    s_waitcnt lgkmcnt(0)
    s_or_b32 s50, s48, 1
    v_mov_b32 v6, s50
    s_mov_b64 exec, 1
    global_atomic_cmpswap v4, v[6:7], s[26:27] sc1
    s_mov_b64 exec, -1
L_g_poll0:
    s_waitcnt lgkmcnt(0)
    s_barrier
    s_mov_b64 exec, 1
L_g_np:
    global_load_dword v5, v4, s[26:27] sc1
    s_waitcnt vmcnt(0)
    v_readfirstlane_b32 s60, v5
    s_cmp_lg_u32 s60, 0
    s_cbranch_scc1 L_g_npd
    s_sub_u32 s96, s96, 1
    s_cmp_gt_i32 s96, 0
    s_cbranch_scc1 L_g_np
    s_mov_b32 s60, 1
    v_mov_b32 v5, 1
L_g_npd:
    v_mov_b32 v2, 163348
    ds_write_b32 v2, v5
    s_mov_b64 exec, -1
    s_not_b32 s61, s60
    v_lshlrev_b32 v1, 4, v0
    s_lshl_b32 s48, s31, 12
    v_add_u32 v4, s48, v1
    v_add_u32 v5, 32768, v4
    v_add_u32 v6, 65536, v4
    v_add_u32 v7, 98304, v4
    s_mov_b32 s48, 0xffff
    v_mov_b32 v2, 162816
L_g_qw:
    s_sleep 2
    ds_read_b32 v3, v2
    s_waitcnt lgkmcnt(0)
    v_readfirstlane_b32 s49, v3
    s_cmp_ge_i32 s49, 7
    s_cbranch_scc1 L_g_qwd
    s_sub_u32 s96, s96, 1
    s_cmp_gt_i32 s96, 0
    s_cbranch_scc1 L_g_qw
L_g_qwd:
L_q_poll:
    s_bitcmp1_b32 s48, 0
    s_cbranch_scc0 L_qs6
    global_load_dwordx4 v[128:131], v4, s[28:29] offset:0 sc1
L_qs6:
    s_bitcmp1_b32 s48, 1
    s_cbranch_scc0 L_qs7
    global_load_dwordx4 v[132:135], v4, s[28:29] offset:1024 sc1
L_qs7:
    s_bitcmp1_b32 s48, 2
    s_cbranch_scc0 L_qs8
    global_load_dwordx4 v[136:139], v4, s[28:29] offset:2048 sc1
L_qs8:
    s_bitcmp1_b32 s48, 3
    s_cbranch_scc0 L_qs9
    global_load_dwordx4 v[140:143], v4, s[28:29] offset:3072 sc1
L_qs9:
    s_bitcmp1_b32 s48, 4
    s_cbranch_scc0 L_qs10
    global_load_dwordx4 v[144:147], v5, s[28:29] offset:0 sc1
L_qs10:
    s_bitcmp1_b32 s48, 5
    s_cbranch_scc0 L_qs11
    global_load_dwordx4 v[148:151], v5, s[28:29] offset:1024 sc1
L_qs11:
    s_bitcmp1_b32 s48, 6
    s_cbranch_scc0 L_qs12
    global_load_dwordx4 v[152:155], v5, s[28:29] offset:2048 sc1
L_qs12:
    s_bitcmp1_b32 s48, 7
    s_cbranch_scc0 L_qs13
    global_load_dwordx4 v[156:159], v5, s[28:29] offset:3072 sc1
L_qs13:
    s_bitcmp1_b32 s48, 8
    s_cbranch_scc0 L_qs14
    global_load_dwordx4 v[160:163], v6, s[28:29] offset:0 sc1
L_qs14:
    s_bitcmp1_b32 s48, 9
    s_cbranch_scc0 L_qs15
    global_load_dwordx4 v[164:167], v6, s[28:29] offset:1024 sc1
L_qs15:
    s_bitcmp1_b32 s48, 10
    s_cbranch_scc0 L_qs16
    global_load_dwordx4 v[168:171], v6, s[28:29] offset:2048 sc1
L_qs16:
    s_bitcmp1_b32 s48, 11
    s_cbranch_scc0 L_qs17
    global_load_dwordx4 v[172:175], v6, s[28:29] offset:3072 sc1
L_qs17:
    s_bitcmp1_b32 s48, 12
    s_cbranch_scc0 L_qs18
    global_load_dwordx4 v[176:179], v7, s[28:29] offset:0 sc1
L_qs18:
    s_bitcmp1_b32 s48, 13
    s_cbranch_scc0 L_qs19
    global_load_dwordx4 v[180:183], v7, s[28:29] offset:1024 sc1
L_qs19:
    s_bitcmp1_b32 s48, 14
    s_cbranch_scc0 L_qs20
    global_load_dwordx4 v[184:187], v7, s[28:29] offset:2048 sc1
L_qs20:
    s_bitcmp1_b32 s48, 15
    s_cbranch_scc0 L_qs21
    global_load_dwordx4 v[188:191], v7, s[28:29] offset:3072 sc1
L_qs21:
    s_mov_b32 s48, 0
    s_waitcnt vmcnt(0)
    v_cmp_ne_u32 s[64:65], s60, v129
    v_cmp_ne_u32 s[66:67], s61, v131
    s_or_b64 s[64:65], s[64:65], s[66:67]
    s_cselect_b32 s49, 1, 0
    s_or_b32 s48, s48, s49
    v_cmp_ne_u32 s[64:65], s60, v133
    v_cmp_ne_u32 s[66:67], s61, v135
    s_or_b64 s[64:65], s[64:65], s[66:67]
    s_cselect_b32 s49, 2, 0
    s_or_b32 s48, s48, s49
    v_cmp_ne_u32 s[64:65], s60, v137
    v_cmp_ne_u32 s[66:67], s61, v139
    s_or_b64 s[64:65], s[64:65], s[66:67]
    s_cselect_b32 s49, 4, 0
    s_or_b32 s48, s48, s49
    v_cmp_ne_u32 s[64:65], s60, v141
    v_cmp_ne_u32 s[66:67], s61, v143
    s_or_b64 s[64:65], s[64:65], s[66:67]
    s_cselect_b32 s49, 8, 0
    s_or_b32 s48, s48, s49
    v_cmp_ne_u32 s[64:65], s60, v145
    v_cmp_ne_u32 s[66:67], s61, v147
    s_or_b64 s[64:65], s[64:65], s[66:67]
    s_cselect_b32 s49, 16, 0
    s_or_b32 s48, s48, s49
    v_cmp_ne_u32 s[64:65], s60, v149
    v_cmp_ne_u32 s[66:67], s61, v151
    s_or_b64 s[64:65], s[64:65], s[66:67]
    s_cselect_b32 s49, 32, 0
    s_or_b32 s48, s48, s49
    v_cmp_ne_u32 s[64:65], s60, v153
    v_cmp_ne_u32 s[66:67], s61, v155
    s_or_b64 s[64:65], s[64:65], s[66:67]
    s_cselect_b32 s49, 64, 0
    s_or_b32 s48, s48, s49
    v_cmp_ne_u32 s[64:65], s60, v157
    v_cmp_ne_u32 s[66:67], s61, v159
    s_or_b64 s[64:65], s[64:65], s[66:67]
    s_cselect_b32 s49, 128, 0
    s_or_b32 s48, s48, s49
    v_cmp_ne_u32 s[64:65], s60, v161
    v_cmp_ne_u32 s[66:67], s61, v163
    s_or_b64 s[64:65], s[64:65], s[66:67]
    s_cselect_b32 s49, 256, 0
    s_or_b32 s48, s48, s49
    v_cmp_ne_u32 s[64:65], s60, v165
    v_cmp_ne_u32 s[66:67], s61, v167
    s_or_b64 s[64:65], s[64:65], s[66:67]
    s_cselect_b32 s49, 512, 0
    s_or_b32 s48, s48, s49
    v_cmp_ne_u32 s[64:65], s60, v169
    v_cmp_ne_u32 s[66:67], s61, v171
    s_or_b64 s[64:65], s[64:65], s[66:67]
    s_cselect_b32 s49, 1024, 0
    s_or_b32 s48, s48, s49
    v_cmp_ne_u32 s[64:65], s60, v173
    v_cmp_ne_u32 s[66:67], s61, v175
    s_or_b64 s[64:65], s[64:65], s[66:67]
    s_cselect_b32 s49, 2048, 0
    s_or_b32 s48, s48, s49
    v_cmp_ne_u32 s[64:65], s60, v177
    v_cmp_ne_u32 s[66:67], s61, v179
    s_or_b64 s[64:65], s[64:65], s[66:67]
    s_cselect_b32 s49, 4096, 0
    s_or_b32 s48, s48, s49
    v_cmp_ne_u32 s[64:65], s60, v181
    v_cmp_ne_u32 s[66:67], s61, v183
    s_or_b64 s[64:65], s[64:65], s[66:67]
    s_cselect_b32 s49, 8192, 0
    s_or_b32 s48, s48, s49
    v_cmp_ne_u32 s[64:65], s60, v185
    v_cmp_ne_u32 s[66:67], s61, v187
    s_or_b64 s[64:65], s[64:65], s[66:67]
    s_cselect_b32 s49, 16384, 0
    s_or_b32 s48, s48, s49
    v_cmp_ne_u32 s[64:65], s60, v189
    v_cmp_ne_u32 s[66:67], s61, v191
    s_or_b64 s[64:65], s[64:65], s[66:67]
    s_cselect_b32 s49, 32768, 0
    s_or_b32 s48, s48, s49
    s_cmp_eq_u32 s48, 0
    s_cbranch_scc1 L_q_done
    s_sub_u32 s96, s96, 1
    s_cmp_gt_i32 s96, 0
    s_cbranch_scc1 L_q_poll
L_q_done:
    v_lshlrev_b32 v1, 2, v0
    v_add_u32 v1, 161792, v1
    v_add_f32 v128, v128, v144
    v_add_f32 v160, v160, v176
    v_add_f32 v128, v128, v160
    v_add_f32 v130, v130, v146
    v_add_f32 v162, v162, v178
    v_add_f32 v130, v130, v162
    v_cvt_pk_bf16_f32 v128, v128, v130
    ds_write_b32 v1, v128 offset:0
    v_add_f32 v132, v132, v148
    v_add_f32 v164, v164, v180
    v_add_f32 v132, v132, v164
    v_add_f32 v134, v134, v150
    v_add_f32 v166, v166, v182
    v_add_f32 v134, v134, v166
    v_cvt_pk_bf16_f32 v132, v132, v134
    ds_write_b32 v1, v132 offset:256
    v_add_f32 v136, v136, v152
    v_add_f32 v168, v168, v184
    v_add_f32 v136, v136, v168
    v_add_f32 v138, v138, v154
    v_add_f32 v170, v170, v186
    v_add_f32 v138, v138, v170
    v_cvt_pk_bf16_f32 v136, v136, v138
    ds_write_b32 v1, v136 offset:512
    v_add_f32 v140, v140, v156
    v_add_f32 v172, v172, v188
    v_add_f32 v140, v140, v172
    v_add_f32 v142, v142, v158
    v_add_f32 v174, v174, v190
    v_add_f32 v142, v142, v174
    v_cvt_pk_bf16_f32 v140, v140, v142
    ds_write_b32 v1, v140 offset:768
    v_mov_b32 v2, 163340
    v_mov_b32 v3, 1
    s_waitcnt lgkmcnt(0)
    s_mov_b64 exec, 1
    ds_add_u32 v2, v3
    s_mov_b64 exec, -1
    v_mov_b32 v2, 163328
L_g_sw:
    s_sleep 8
    ds_read_b96 v[8:10], v2
    s_waitcnt lgkmcnt(0)
    v_min3_u32 v8, v8, v9, v10
    s_nop 0
    v_readfirstlane_b32 s48, v8
    s_cmp_ge_u32 s48, 18
    s_cbranch_scc1 L_g_swd
    s_sub_u32 s96, s96, 1
    s_cmp_gt_i32 s96, 0
    s_cbranch_scc1 L_g_sw
L_g_swd:
    v_lshlrev_b32 v3, 4, v0
    v_add_u32 v3, 147456, v3
    ds_read_b128 v[8:11], v3
    ds_read_b128 v[12:15], v3 offset:1024
    s_mul_i32 s48, s31, 53248
    s_lshl_b32 s49, s3, 7
    s_add_u32 s48, s48, s49
    s_add_u32 s48, s48, 393216
    v_lshrrev_b32 v4, 3, v0
    v_lshlrev_b32 v4, 12, v4
    v_and_b32 v5, 7, v0
    v_lshl_add_u32 v4, v5, 4, v4
    v_add_u32 v4, s48, v4
    v_add_u32 v5, 32768, v4
    s_mul_i32 s48, s31, 16384
    s_add_u32 s48, s48, 270336
    v_mov_b32 v6, s48
    v_mov_b32 v7, 1
    s_waitcnt lgkmcnt(0)
    global_store_dwordx4 v4, v[8:11], s[28:29] sc1 nt
    s_mov_b32 s48, 0xffffffff
    s_mov_b32 s49, 0xff
    s_mov_b64 exec, s[48:49]
    global_store_dwordx4 v5, v[12:15], s[28:29] sc1 nt
    s_mov_b64 exec, 1
    s_waitcnt vmcnt(0)
    v_mov_b32 v9, 162816
    s_lshl_b32 s48, s31, 8
    s_add_u32 s48, s48, 987136
    v_mov_b32 v6, s48
    v_mov_b32 v10, s60
L_g_aw:
    s_sleep 4
    ds_read_b32 v8, v9
    s_waitcnt lgkmcnt(0)
    v_readfirstlane_b32 s48, v8
    s_cmp_ge_i32 s48, 190
    s_cbranch_scc1 L_g_aw2
    s_sub_u32 s96, s96, 1
    s_cmp_gt_i32 s96, 0
    s_cbranch_scc1 L_g_aw
L_g_aw2:
    s_memrealtime s[50:51]
    s_waitcnt lgkmcnt(0)
    s_sub_u32 s48, s50, s60
    s_min_u32 s48, s48, 0xfffff
L_g_post:
    s_mov_b64 exec, -1
    s_lshl_b32 s49, s2, 7
    s_add_u32 s49, s49, 950272
    v_lshl_add_u32 v6, v0, 4, s49
    v_and_b32 v12, 2, v0
    v_lshlrev_b32 v12, 2, v12
    v_add_u32 v12, 163424, v12
    s_mov_b32 s50, 0x3db8aa3b
    ds_read_b64 v[14:15], v12 offset:0
    ds_read_b64 v[16:17], v12 offset:16
    ds_read_b64 v[18:19], v12 offset:32
    s_waitcnt lgkmcnt(0)
    v_max3_f32 v8, v14, v16, v18
    v_sub_f32 v14, v14, v8
    v_sub_f32 v16, v16, v8
    v_sub_f32 v18, v18, v8
    v_mul_f32 v14, s50, v14
    v_mul_f32 v16, s50, v16
    v_mul_f32 v18, s50, v18
    v_exp_f32 v14, v14
    v_exp_f32 v16, v16
    v_exp_f32 v18, v18
    s_nop 0
    v_mul_f32 v10, v14, v15
    v_fmac_f32 v10, v16, v17
    v_fmac_f32 v10, v18, v19
    v_writelane_b32 v8, s48, 0
    v_mov_b32 v9, s60
    v_mov_b32 v11, s61
    s_mov_b64 exec, 15
    global_store_dwordx4 v6, v[8:11], s[28:29] sc1
    s_mov_b64 exec, -1
    s_lshl_b32 s48, s31, 12
    s_add_u32 s48, s48, 950272
    v_and_b32 v6, 31, v0
    v_lshl_add_u32 v6, v6, 7, s48
    s_waitcnt vmcnt(0)
    v_mov_b32 v12, 162816
L_g_bw:
    s_sleep 4
    ds_read_b32 v8, v12
    s_waitcnt lgkmcnt(0)
    v_readfirstlane_b32 s48, v8
    s_cmp_ge_i32 s48, 220
    s_cbranch_scc1 L_g_pw1
    s_sub_u32 s96, s96, 1
    s_cmp_gt_i32 s96, 0
    s_cbranch_scc1 L_g_bw
L_g_pw:
    s_sleep 12
L_g_pw1:
    v_lshrrev_b32 v13, 5, v0
    v_lshl_add_u32 v13, v13, 4, v6
    global_load_dwordx4 v[8:11], v6, s[28:29] sc1
    global_load_dwordx4 v[16:19], v13, s[28:29] offset:16 sc1
    s_waitcnt vmcnt(0)
    v_cmp_ne_u32 s[64:65], s60, v9
    v_cmp_ne_u32 s[66:67], s61, v11
    v_cmp_ne_u32 s[68:69], s60, v17
    v_cmp_ne_u32 s[70:71], s61, v19
    s_or_b64 s[64:65], s[64:65], s[66:67]
    s_or_b64 s[68:69], s[68:69], s[70:71]
    s_or_b64 s[64:65], s[64:65], s[68:69]
    s_cbranch_scc0 L_g_pwd
    s_sub_u32 s96, s96, 1
    s_cmp_gt_i32 s96, 0
    s_cbranch_scc1 L_g_pw
L_g_pwd:
    v_mov_b32 v20, v16
    s_nop 1
    v_max_f32_dpp v20, v20, v20 row_ror:8 row_mask:0xf bank_mask:0xf
    s_nop 1
    v_max_f32_dpp v20, v20, v20 row_ror:4 row_mask:0xf bank_mask:0xf
    s_nop 1
    v_max_f32_dpp v20, v20, v20 row_ror:2 row_mask:0xf bank_mask:0xf
    s_nop 1
    v_max_f32_dpp v20, v20, v20 row_ror:1 row_mask:0xf bank_mask:0xf
    v_mov_b32 v21, v20
    s_nop 1
    v_permlane16_swap_b32 v20, v21
    v_max_f32 v20, v20, v21
    v_sub_f32 v16, v16, v20
    v_mul_f32 v16, s50, v16
    v_exp_f32 v16, v16
    s_nop 0
    v_mul_f32 v16, v16, v18
    s_nop 1
    v_add_f32_dpp v16, v16, v16 row_ror:8 row_mask:0xf bank_mask:0xf
    s_nop 1
    v_add_f32_dpp v16, v16, v16 row_ror:4 row_mask:0xf bank_mask:0xf
    s_nop 1
    v_add_f32_dpp v16, v16, v16 row_ror:2 row_mask:0xf bank_mask:0xf
    s_nop 1
    v_add_f32_dpp v16, v16, v16 row_ror:1 row_mask:0xf bank_mask:0xf
    v_mov_b32 v21, v16
    s_nop 1
    v_permlane16_swap_b32 v16, v21
    v_add_f32 v16, v16, v21
    v_rcp_f32 v16, v16
    v_lshrrev_b32 v13, 5, v0
    v_lshlrev_b32 v13, 2, v13
    v_add_u32 v13, 163376, v13
    ds_write_b32 v13, v20
    ds_write_b32 v13, v16 offset:8
    v_mov_b32 v12, v8
    s_nop 1
    v_add_u32_dpp v12, v12, v12 row_ror:8 row_mask:0xf bank_mask:0xf
    s_nop 1
    v_add_u32_dpp v12, v12, v12 row_ror:4 row_mask:0xf bank_mask:0xf
    s_nop 1
    v_add_u32_dpp v12, v12, v12 row_ror:2 row_mask:0xf bank_mask:0xf
    s_nop 1
    v_add_u32_dpp v12, v12, v12 row_ror:1 row_mask:0xf bank_mask:0xf
    v_mov_b32 v13, v12
    s_nop 1
    v_permlane16_swap_b32 v12, v13
    v_add_u32 v12, v12, v13
    v_lshlrev_b32 v8, 5, v8
    v_sub_u32 v8, v12, v8
    v_cvt_f32_u32 v12, v12
    v_cvt_f32_i32 v8, v8
    v_rcp_f32 v12, v12
    v_mul_f32 v8, 0x42be0000, v8
    v_mov_b32 v13, 0x41380000
    v_fma_f32 v8, v8, v12, v13
    v_cvt_i32_f32 v8, v8
    v_med3_i32 v8, v8, 2, 31
    v_mov_b32 v12, v8
    s_nop 1
    v_add_u32_dpp v12, v12, v12 row_ror:8 row_mask:0xf bank_mask:0xf
    s_nop 1
    v_add_u32_dpp v12, v12, v12 row_ror:4 row_mask:0xf bank_mask:0xf
    s_nop 1
    v_add_u32_dpp v12, v12, v12 row_ror:2 row_mask:0xf bank_mask:0xf
    s_nop 1
    v_add_u32_dpp v12, v12, v12 row_ror:1 row_mask:0xf bank_mask:0xf
    s_nop 0
    v_readlane_b32 s48, v12, 0
    v_readlane_b32 s49, v12, 16
    s_add_u32 s48, s48, s49
    s_cmp_le_u32 s48, 416
    s_cbranch_scc1 L_g_nok
    v_mov_b32 v8, 2
L_g_nok:
    s_lshl_b32 s52, 1, s3
    s_sub_u32 s52, s52, 1
    s_mov_b32 s50, 0
    s_mov_b32 s51, 0
    v_mov_b32 v14, 0
L_g_lst:
    v_cmp_lt_u32 vcc, s50, v8
    s_mov_b32 m0, s50
    s_and_b32 s48, vcc_lo, s52
    s_bcnt1_i32_b32 s48, s48
    s_add_u32 s48, s48, s51
    v_writelane_b32 v14, s48, m0
    s_add_u32 s50, s50, 1
    s_bcnt1_i32_b32 s49, vcc_lo
    s_add_u32 s51, s51, s49
    s_cmp_lg_u32 s49, 0
    s_cbranch_scc1 L_g_lst
    v_readlane_b32 s48, v8, s3
    v_writelane_b32 v14, s51, 33
    v_lshlrev_b32 v3, 2, v0
    v_add_u32 v3, 161792, v3
    v_writelane_b32 v14, s48, 32
    v_mov_b32 v7, 1
    ds_write_b32 v3, v14
    ds_write_b32 v2, v7 offset:24
    s_mov_b64 exec, -1
    s_mov_b32 s57, 0xffff0000
    s_mov_b32 s54, 0xbfb8aa3b
    v_lshlrev_b32 v1, 4, v0
    v_add_u32 v5, 149504, v1
    v_mov_b32 v7, 162816
    v_mov_b32 v16, 0
    v_mov_b32 v17, 0
    v_mov_b32 v18, 0
    v_mov_b32 v19, 0
    v_mov_b32 v20, 0
    v_mov_b32 v21, 0
    v_mov_b32 v22, 0
    v_mov_b32 v23, 0
    s_cmp_lt_u32 s2, 224
    s_cselect_b32 s59, 1, 0
    s_cbranch_scc0 L_f_wait
    s_and_b32 s52, s2, 1
    s_cmp_eq_u32 s52, 0
    s_cselect_b32 s46, s16, s18
    s_cselect_b32 s47, s17, s19
    s_mov_b32 s40, s46
    s_and_b32 s41, s47, 0xffff
    s_mov_b32 s42, 0x188000
    s_mov_b32 s43, 0x20000
    s_mov_b32 s44, s20
    s_and_b32 s45, s21, 0xffff
    s_mov_b32 s46, 0x188000
    s_mov_b32 s47, 0x20000
    s_bfe_u32 s50, s2, 0x20001
    s_lshr_b32 s51, s2, 3
    s_mul_i32 s55, s50, 401408
    s_lshl_b32 s53, s51, 7
    s_add_u32 s55, s55, s53
    s_lshl_b32 s48, s52, 2
    s_add_u32 s48, s48, s50
    s_lshl_b32 s48, s48, 14
    s_lshl_b32 s53, s51, 9
    s_add_u32 s48, s48, s53
    s_add_u32 s48, s48, 131072
    v_lshl_add_u32 v12, v0, 4, s48
    v_lshrrev_b32 v2, 3, v0
    v_mul_u32_u24 v4, 3584, v2
    v_and_b32 v3, 7, v0
    v_lshl_add_u32 v4, v3, 4, v4
    s_mul_i32 s50, s50, 224
    v_lshl_add_u32 v2, v2, 1, s50
    global_load_ushort v48, v2, s[4:5] offset:0
    global_load_ushort v49, v2, s[4:5] offset:16
    global_load_ushort v50, v2, s[4:5] offset:32
    global_load_ushort v51, v2, s[4:5] offset:48
    global_load_ushort v52, v2, s[4:5] offset:64
    global_load_ushort v53, v2, s[4:5] offset:80
    global_load_ushort v54, v2, s[4:5] offset:96
    global_load_ushort v55, v2, s[4:5] offset:112
    global_load_ushort v56, v2, s[4:5] offset:128
    global_load_ushort v57, v2, s[4:5] offset:144
    global_load_ushort v58, v2, s[4:5] offset:160
    global_load_ushort v59, v2, s[4:5] offset:176
    global_load_ushort v60, v2, s[4:5] offset:192
    global_load_ushort v61, v2, s[4:5] offset:208
    v_bfe_u32 v8, v0, 1, 2
    v_cmp_eq_u32 s[64:65], 0, v8
    v_cmp_eq_u32 s[66:67], 1, v8
    v_cmp_eq_u32 s[68:69], 2, v8
    v_cmp_eq_u32 s[70:71], 3, v8
    v_and_b32 v8, 1, v0
    v_lshlrev_b32 v8, 4, v8
    s_waitcnt vmcnt(0)
    v_lshlrev_b32 v48, v8, v48
    v_cndmask_b32 v128, 0, v48, s[64:65]
    v_cndmask_b32 v129, 0, v48, s[66:67]
    v_cndmask_b32 v130, 0, v48, s[68:69]
    v_cndmask_b32 v131, 0, v48, s[70:71]
    v_lshlrev_b32 v49, v8, v49
    v_cndmask_b32 v132, 0, v49, s[64:65]
    v_cndmask_b32 v133, 0, v49, s[66:67]
    v_cndmask_b32 v134, 0, v49, s[68:69]
    v_cndmask_b32 v135, 0, v49, s[70:71]
    v_lshlrev_b32 v50, v8, v50
    v_cndmask_b32 v136, 0, v50, s[64:65]
    v_cndmask_b32 v137, 0, v50, s[66:67]
    v_cndmask_b32 v138, 0, v50, s[68:69]
    v_cndmask_b32 v139, 0, v50, s[70:71]
    v_lshlrev_b32 v51, v8, v51
    v_cndmask_b32 v140, 0, v51, s[64:65]
    v_cndmask_b32 v141, 0, v51, s[66:67]
    v_cndmask_b32 v142, 0, v51, s[68:69]
    v_cndmask_b32 v143, 0, v51, s[70:71]
    v_lshlrev_b32 v52, v8, v52
    v_cndmask_b32 v144, 0, v52, s[64:65]
    v_cndmask_b32 v145, 0, v52, s[66:67]
    v_cndmask_b32 v146, 0, v52, s[68:69]
    v_cndmask_b32 v147, 0, v52, s[70:71]
    v_lshlrev_b32 v53, v8, v53
    v_cndmask_b32 v148, 0, v53, s[64:65]
    v_cndmask_b32 v149, 0, v53, s[66:67]
    v_cndmask_b32 v150, 0, v53, s[68:69]
    v_cndmask_b32 v151, 0, v53, s[70:71]
    v_lshlrev_b32 v54, v8, v54
    v_cndmask_b32 v152, 0, v54, s[64:65]
    v_cndmask_b32 v153, 0, v54, s[66:67]
    v_cndmask_b32 v154, 0, v54, s[68:69]
    v_cndmask_b32 v155, 0, v54, s[70:71]
    v_lshlrev_b32 v55, v8, v55
    v_cndmask_b32 v156, 0, v55, s[64:65]
    v_cndmask_b32 v157, 0, v55, s[66:67]
    v_cndmask_b32 v158, 0, v55, s[68:69]
    v_cndmask_b32 v159, 0, v55, s[70:71]
    v_lshlrev_b32 v56, v8, v56
    v_cndmask_b32 v160, 0, v56, s[64:65]
    v_cndmask_b32 v161, 0, v56, s[66:67]
    v_cndmask_b32 v162, 0, v56, s[68:69]
    v_cndmask_b32 v163, 0, v56, s[70:71]
    v_lshlrev_b32 v57, v8, v57
    v_cndmask_b32 v164, 0, v57, s[64:65]
    v_cndmask_b32 v165, 0, v57, s[66:67]
    v_cndmask_b32 v166, 0, v57, s[68:69]
    v_cndmask_b32 v167, 0, v57, s[70:71]
    v_lshlrev_b32 v58, v8, v58
    v_cndmask_b32 v168, 0, v58, s[64:65]
    v_cndmask_b32 v169, 0, v58, s[66:67]
    v_cndmask_b32 v170, 0, v58, s[68:69]
    v_cndmask_b32 v171, 0, v58, s[70:71]
    v_lshlrev_b32 v59, v8, v59
    v_cndmask_b32 v172, 0, v59, s[64:65]
    v_cndmask_b32 v173, 0, v59, s[66:67]
    v_cndmask_b32 v174, 0, v59, s[68:69]
    v_cndmask_b32 v175, 0, v59, s[70:71]
    v_lshlrev_b32 v60, v8, v60
    v_cndmask_b32 v176, 0, v60, s[64:65]
    v_cndmask_b32 v177, 0, v60, s[66:67]
    v_cndmask_b32 v178, 0, v60, s[68:69]
    v_cndmask_b32 v179, 0, v60, s[70:71]
    v_lshlrev_b32 v61, v8, v61
    v_cndmask_b32 v180, 0, v61, s[64:65]
    v_cndmask_b32 v181, 0, v61, s[66:67]
    v_cndmask_b32 v182, 0, v61, s[68:69]
    v_cndmask_b32 v183, 0, v61, s[70:71]
    v_mov_b32 v41, s60
    v_mov_b32 v43, s61
    v_and_b32 v14, 1, v0
    v_cmp_eq_u32 vcc, 1, v14
    v_mov_b32 v14, s60
    v_mov_b32 v15, s61
    v_cndmask_b32 v27, v14, v15, vcc
    s_lshl_b32 s48, s2, 6
    s_add_u32 s48, s48, 131072
    v_bfe_u32 v24, v0, 2, 3
    v_lshlrev_b32 v24, 14, v24
    v_and_b32 v25, 3, v0
    v_lshl_add_u32 v24, v25, 4, v24
    v_add_u32 v6, s48, v24
    s_and_b32 s56, s2, 1
    s_lshl_b32 s56, s56, 5
    s_and_b32 s53, s2, 6
    s_add_u32 s56, s56, s53
    s_lshl_b32 s53, s51, 6
    s_add_u32 s56, s56, s53
    s_mul_i32 s56, s56, 896
    s_waitcnt vmcnt(0)
L_f_wait:
    v_mov_b32 v2, 163364
L_lw_ft:
    ds_read_b32 v3, v2
    s_waitcnt lgkmcnt(0)
    v_readfirstlane_b32 s48, v3
    s_cmp_lg_u32 s48, 0
    s_cbranch_scc1 L_lwd_ft
    s_sleep 2
    s_sub_u32 s96, s96, 1
    s_cmp_gt_i32 s96, 0
    s_cbranch_scc1 L_lw_ft
L_lwd_ft:
L_f_go:
    s_cmp_eq_u32 s59, 0
    s_cbranch_scc1 L_f_out
    buffer_load_dwordx4 v[64:67], v4, s[40:43], s55 offen nt
    s_add_u32 s55, s55, 28672
    buffer_load_dwordx4 v[68:71], v4, s[40:43], s55 offen nt
    s_add_u32 s55, s55, 28672
    buffer_load_dwordx4 v[72:75], v4, s[40:43], s55 offen nt
    s_add_u32 s55, s55, 28672
    buffer_load_dwordx4 v[76:79], v4, s[40:43], s55 offen nt
    s_add_u32 s55, s55, 28672
    buffer_load_dwordx4 v[80:83], v4, s[40:43], s55 offen nt
    s_add_u32 s55, s55, 28672
    buffer_load_dwordx4 v[84:87], v4, s[40:43], s55 offen nt
    s_add_u32 s55, s55, 28672
    buffer_load_dwordx4 v[88:91], v4, s[40:43], s55 offen nt
    s_add_u32 s55, s55, 28672
    buffer_load_dwordx4 v[92:95], v4, s[40:43], s55 offen nt
    s_add_u32 s55, s55, 28672
    buffer_load_dwordx4 v[96:99], v4, s[40:43], s55 offen nt
    s_add_u32 s55, s55, 28672
    buffer_load_dwordx4 v[100:103], v4, s[40:43], s55 offen nt
    s_add_u32 s55, s55, 28672
    buffer_load_dwordx4 v[104:107], v4, s[40:43], s55 offen nt
    s_add_u32 s55, s55, 28672
    buffer_load_dwordx4 v[108:111], v4, s[40:43], s55 offen nt
    s_add_u32 s55, s55, 28672
    buffer_load_dwordx4 v[112:115], v4, s[40:43], s55 offen nt
    s_add_u32 s55, s55, 28672
    buffer_load_dwordx4 v[116:119], v4, s[40:43], s55 offen nt
    s_waitcnt vmcnt(13)
    s_mov_b32 s48, -1
    s_mov_b32 s49, 0xffffff
    s_mov_b64 exec, s[48:49]
    buffer_load_dwordx4 v[192:195], v1, s[44:47], s56 offen offset:0 nt
    buffer_load_dwordx4 v[196:199], v1, s[44:47], s56 offen offset:896 nt
    s_add_u32 s56, s56, 7168
    buffer_load_dwordx4 v[200:203], v1, s[44:47], s56 offen offset:0 nt
    buffer_load_dwordx4 v[204:207], v1, s[44:47], s56 offen offset:896 nt
    s_add_u32 s56, s56, 7168
    buffer_load_dwordx4 v[208:211], v1, s[44:47], s56 offen offset:0 nt
    buffer_load_dwordx4 v[212:215], v1, s[44:47], s56 offen offset:896 nt
    s_add_u32 s56, s56, 7168
    buffer_load_dwordx4 v[216:219], v1, s[44:47], s56 offen offset:0 nt
    buffer_load_dwordx4 v[220:223], v1, s[44:47], s56 offen offset:896 nt
    s_mov_b64 exec, -1
    v_mfma_f32_16x16x32_bf16 v[32:35], v[128:131], v[64:67], 0
    s_waitcnt vmcnt(20)
    v_mfma_f32_16x16x32_bf16 v[32:35], v[132:135], v[68:71], v[32:35]
    s_waitcnt vmcnt(19)
    v_mfma_f32_16x16x32_bf16 v[32:35], v[136:139], v[72:75], v[32:35]
    s_waitcnt vmcnt(18)
    v_mfma_f32_16x16x32_bf16 v[32:35], v[140:143], v[76:79], v[32:35]
    s_waitcnt vmcnt(17)
    v_mfma_f32_16x16x32_bf16 v[32:35], v[144:147], v[80:83], v[32:35]
    s_waitcnt vmcnt(16)
    v_mfma_f32_16x16x32_bf16 v[32:35], v[148:151], v[84:87], v[32:35]
    s_waitcnt vmcnt(15)
    v_mfma_f32_16x16x32_bf16 v[32:35], v[152:155], v[88:91], v[32:35]
    s_waitcnt vmcnt(14)
    v_mfma_f32_16x16x32_bf16 v[32:35], v[156:159], v[92:95], v[32:35]
    s_waitcnt vmcnt(13)
    v_mfma_f32_16x16x32_bf16 v[32:35], v[160:163], v[96:99], v[32:35]
    s_waitcnt vmcnt(12)
    v_mfma_f32_16x16x32_bf16 v[32:35], v[164:167], v[100:103], v[32:35]
    s_waitcnt vmcnt(11)
    v_mfma_f32_16x16x32_bf16 v[32:35], v[168:171], v[104:107], v[32:35]
    s_waitcnt vmcnt(10)
    v_mfma_f32_16x16x32_bf16 v[32:35], v[172:175], v[108:111], v[32:35]
    s_waitcnt vmcnt(9)
    v_mfma_f32_16x16x32_bf16 v[32:35], v[176:179], v[112:115], v[32:35]
    s_waitcnt vmcnt(8)
    v_mfma_f32_16x16x32_bf16 v[32:35], v[180:183], v[116:119], v[32:35]
    s_nop 7
    v_mov_b32 v36, v32
    v_mov_b32 v37, v33
    v_mov_b32 v38, v34
    v_mov_b32 v39, v35
    v_permlane32_swap_b32 v32, v36
    v_permlane32_swap_b32 v33, v37
    v_permlane32_swap_b32 v34, v38
    v_permlane32_swap_b32 v35, v39
    v_add_f32_dpp v40, v36, v32 row_ror:8 row_mask:0xf bank_mask:0x3
    v_add_f32_dpp v42, v37, v33 row_ror:8 row_mask:0xf bank_mask:0x3
    v_add_f32_dpp v40, v34, v38 row_ror:8 row_mask:0xf bank_mask:0xc
    v_add_f32_dpp v42, v35, v39 row_ror:8 row_mask:0xf bank_mask:0xc
    s_mov_b32 exec_hi, 0
    global_store_dwordx4 v12, v[40:43], s[28:29] sc1
    s_mov_b64 exec, -1
    s_waitcnt vmcnt(7)
    v_lshlrev_b32 v64, 16, v192
    v_and_b32 v65, s57, v192
    v_lshlrev_b32 v66, 16, v193
    v_and_b32 v67, s57, v193
    v_lshlrev_b32 v68, 16, v194
    v_and_b32 v69, s57, v194
    v_lshlrev_b32 v70, 16, v195
    v_and_b32 v71, s57, v195
    s_waitcnt vmcnt(6)
    v_lshlrev_b32 v72, 16, v196
    v_and_b32 v73, s57, v196
    v_lshlrev_b32 v74, 16, v197
    v_and_b32 v75, s57, v197
    v_lshlrev_b32 v76, 16, v198
    v_and_b32 v77, s57, v198
    v_lshlrev_b32 v78, 16, v199
    v_and_b32 v79, s57, v199
    s_waitcnt vmcnt(5)
    v_lshlrev_b32 v80, 16, v200
    v_and_b32 v81, s57, v200
    v_lshlrev_b32 v82, 16, v201
    v_and_b32 v83, s57, v201
    v_lshlrev_b32 v84, 16, v202
    v_and_b32 v85, s57, v202
    v_lshlrev_b32 v86, 16, v203
    v_and_b32 v87, s57, v203
    s_waitcnt vmcnt(4)
    v_lshlrev_b32 v88, 16, v204
    v_and_b32 v89, s57, v204
    v_lshlrev_b32 v90, 16, v205
    v_and_b32 v91, s57, v205
    v_lshlrev_b32 v92, 16, v206
    v_and_b32 v93, s57, v206
    v_lshlrev_b32 v94, 16, v207
    v_and_b32 v95, s57, v207
    s_waitcnt vmcnt(3)
    v_lshlrev_b32 v96, 16, v208
    v_and_b32 v97, s57, v208
    v_lshlrev_b32 v98, 16, v209
    v_and_b32 v99, s57, v209
    v_lshlrev_b32 v100, 16, v210
    v_and_b32 v101, s57, v210
    v_lshlrev_b32 v102, 16, v211
    v_and_b32 v103, s57, v211
    s_waitcnt vmcnt(2)
    v_lshlrev_b32 v104, 16, v212
    v_and_b32 v105, s57, v212
    v_lshlrev_b32 v106, 16, v213
    v_and_b32 v107, s57, v213
    v_lshlrev_b32 v108, 16, v214
    v_and_b32 v109, s57, v214
    v_lshlrev_b32 v110, 16, v215
    v_and_b32 v111, s57, v215
    s_waitcnt vmcnt(1)
    v_lshlrev_b32 v112, 16, v216
    v_and_b32 v113, s57, v216
    v_lshlrev_b32 v114, 16, v217
    v_and_b32 v115, s57, v217
    v_lshlrev_b32 v116, 16, v218
    v_and_b32 v117, s57, v218
    v_lshlrev_b32 v118, 16, v219
    v_and_b32 v119, s57, v219
    s_waitcnt vmcnt(0)
    v_lshlrev_b32 v120, 16, v220
    v_and_b32 v121, s57, v220
    v_lshlrev_b32 v122, 16, v221
    v_and_b32 v123, s57, v221
    v_lshlrev_b32 v124, 16, v222
    v_and_b32 v125, s57, v222
    v_lshlrev_b32 v126, 16, v223
    v_and_b32 v127, s57, v223
    s_waitcnt vmcnt(0)
L_fg_poll:
    global_load_dwordx4 v[28:31], v6, s[28:29] sc1
    s_waitcnt vmcnt(0)
    v_cmp_ne_u32 s[64:65], s60, v29
    v_cmp_ne_u32 s[66:67], s61, v31
    s_or_b64 s[64:65], s[64:65], s[66:67]
    s_cbranch_scc0 L_fg_ok
    s_sleep 1
    s_sub_u32 s96, s96, 1
    s_cmp_gt_i32 s96, 0
    s_cbranch_scc1 L_fg_poll
L_fg_ok:
    s_nop 1
    v_add_f32_dpp v28, v28, v28 row_ror:4 row_mask:0xf bank_mask:0xf
    v_add_f32_dpp v30, v30, v30 row_ror:4 row_mask:0xf bank_mask:0xf
    s_nop 1
    v_add_f32_dpp v28, v28, v28 row_ror:8 row_mask:0xf bank_mask:0xf
    v_add_f32_dpp v30, v30, v30 row_ror:8 row_mask:0xf bank_mask:0xf
    v_cvt_pk_bf16_f32 v8, v28, v30
    v_mov_b32 v10, v8
    s_nop 1
    v_permlane16_swap_b32 v8, v10
    v_lshlrev_b32 v12, 16, v8
    v_and_b32 v13, s57, v8
    v_mul_f32 v14, s54, v12
    v_mul_f32 v15, s54, v13
    v_exp_f32 v14, v14
    v_exp_f32 v15, v15
    s_nop 0
    v_add_f32 v14, 1.0, v14
    v_add_f32 v15, 1.0, v15
    v_rcp_f32 v14, v14
    v_rcp_f32 v15, v15
    s_nop 0
    v_mul_f32 v12, v12, v14
    v_mul_f32 v13, v13, v15
    v_cvt_pk_bf16_f32 v8, v12, v13
    v_lshlrev_b32 v12, 16, v8
    v_and_b32 v13, s57, v8
    v_lshlrev_b32 v14, 16, v10
    v_and_b32 v15, s57, v10
    v_mul_f32 v12, v12, v14
    v_mul_f32 v13, v13, v15
    v_cvt_pk_bf16_f32 v8, v12, v13
    v_lshlrev_b32 v12, 16, v8
    v_and_b32 v13, s57, v8
    s_nop 0
    v_readlane_b32 s72, v12, 0
    v_readlane_b32 s73, v13, 0
    v_readlane_b32 s74, v12, 1
    v_readlane_b32 s75, v13, 1
    v_readlane_b32 s76, v12, 2
    v_readlane_b32 s77, v13, 2
    v_readlane_b32 s78, v12, 3
    v_readlane_b32 s79, v13, 3
    s_nop 0
    v_pk_mul_f32 v[16:17], v[64:65], s[72:73] op_sel_hi:[1,0]
    v_pk_mul_f32 v[18:19], v[66:67], s[72:73] op_sel_hi:[1,0]
    v_pk_mul_f32 v[20:21], v[68:69], s[72:73] op_sel_hi:[1,0]
    v_pk_mul_f32 v[22:23], v[70:71], s[72:73] op_sel_hi:[1,0]
    v_pk_fma_f32 v[16:17], v[72:73], s[72:73], v[16:17] op_sel:[0,1,0] op_sel_hi:[1,1,1]
    v_pk_fma_f32 v[18:19], v[74:75], s[72:73], v[18:19] op_sel:[0,1,0] op_sel_hi:[1,1,1]
    v_pk_fma_f32 v[20:21], v[76:77], s[72:73], v[20:21] op_sel:[0,1,0] op_sel_hi:[1,1,1]
    v_pk_fma_f32 v[22:23], v[78:79], s[72:73], v[22:23] op_sel:[0,1,0] op_sel_hi:[1,1,1]
    v_pk_fma_f32 v[16:17], v[80:81], s[74:75], v[16:17] op_sel_hi:[1,0,1]
    v_pk_fma_f32 v[18:19], v[82:83], s[74:75], v[18:19] op_sel_hi:[1,0,1]
    v_pk_fma_f32 v[20:21], v[84:85], s[74:75], v[20:21] op_sel_hi:[1,0,1]
    v_pk_fma_f32 v[22:23], v[86:87], s[74:75], v[22:23] op_sel_hi:[1,0,1]
    v_pk_fma_f32 v[16:17], v[88:89], s[74:75], v[16:17] op_sel:[0,1,0] op_sel_hi:[1,1,1]
    v_pk_fma_f32 v[18:19], v[90:91], s[74:75], v[18:19] op_sel:[0,1,0] op_sel_hi:[1,1,1]
    v_pk_fma_f32 v[20:21], v[92:93], s[74:75], v[20:21] op_sel:[0,1,0] op_sel_hi:[1,1,1]
    v_pk_fma_f32 v[22:23], v[94:95], s[74:75], v[22:23] op_sel:[0,1,0] op_sel_hi:[1,1,1]
    v_pk_fma_f32 v[16:17], v[96:97], s[76:77], v[16:17] op_sel_hi:[1,0,1]
    v_pk_fma_f32 v[18:19], v[98:99], s[76:77], v[18:19] op_sel_hi:[1,0,1]
    v_pk_fma_f32 v[20:21], v[100:101], s[76:77], v[20:21] op_sel_hi:[1,0,1]
    v_pk_fma_f32 v[22:23], v[102:103], s[76:77], v[22:23] op_sel_hi:[1,0,1]
    v_pk_fma_f32 v[16:17], v[104:105], s[76:77], v[16:17] op_sel:[0,1,0] op_sel_hi:[1,1,1]
    v_pk_fma_f32 v[18:19], v[106:107], s[76:77], v[18:19] op_sel:[0,1,0] op_sel_hi:[1,1,1]
    v_pk_fma_f32 v[20:21], v[108:109], s[76:77], v[20:21] op_sel:[0,1,0] op_sel_hi:[1,1,1]
    v_pk_fma_f32 v[22:23], v[110:111], s[76:77], v[22:23] op_sel:[0,1,0] op_sel_hi:[1,1,1]
    v_pk_fma_f32 v[16:17], v[112:113], s[78:79], v[16:17] op_sel_hi:[1,0,1]
    v_pk_fma_f32 v[18:19], v[114:115], s[78:79], v[18:19] op_sel_hi:[1,0,1]
    v_pk_fma_f32 v[20:21], v[116:117], s[78:79], v[20:21] op_sel_hi:[1,0,1]
    v_pk_fma_f32 v[22:23], v[118:119], s[78:79], v[22:23] op_sel_hi:[1,0,1]
    v_pk_fma_f32 v[16:17], v[120:121], s[78:79], v[16:17] op_sel:[0,1,0] op_sel_hi:[1,1,1]
    v_pk_fma_f32 v[18:19], v[122:123], s[78:79], v[18:19] op_sel:[0,1,0] op_sel_hi:[1,1,1]
    v_pk_fma_f32 v[20:21], v[124:125], s[78:79], v[20:21] op_sel:[0,1,0] op_sel_hi:[1,1,1]
    v_pk_fma_f32 v[22:23], v[126:127], s[78:79], v[22:23] op_sel:[0,1,0] op_sel_hi:[1,1,1]
L_f_out:
    ds_write_b128 v5, v[16:19]
    ds_write_b128 v5, v[20:23] offset:1024
    ds_write_b32 v7, v7 offset:544
    s_mov_b32 s57, 0xffff0000
    s_lshr_b32 s53, s2, 3
    s_and_b32 s56, s2, 7
    s_mul_i32 s55, s56, 7
    s_add_u32 s55, s55, s53
    s_mul_i32 s55, s55, 16
    s_add_u32 s54, s55, 1572864
    v_mul_u32_u24 v40, 896, v0
    v_add_u32 v40, s54, v40
    v_add_u32 v41, 57344, v40
    v_add_u32 v42, 114688, v40
    v_add_u32 v43, 172032, v40
    v_bfe_u32 v44, v0, 4, 1
    v_lshlrev_b32 v44, 2, v44
    v_bfe_u32 v45, v0, 5, 1
    v_lshl_add_u32 v44, v45, 1, v44
    v_and_b32 v45, 8, v0
    v_add_u32 v44, v44, v45
    v_add_u32 v44, s55, v44
    s_mov_b32 s78, 0x1010101
    s_mov_b32 s79, 0x1010101
    s_lshl_b32 s53, s53, 1
    s_cmp_lt_u32 s53, 14
    s_cbranch_scc0 L_g_fin
    v_mov_b32 v7, 162816
    v_mov_b32 v2, 163356
L_lw_gh1:
    ds_read_b32 v3, v2
    s_waitcnt lgkmcnt(0)
    v_readfirstlane_b32 s48, v3
    s_cmp_lg_u32 s48, 0
    s_cbranch_scc1 L_lwd_gh1
    s_sleep 2
    s_sub_u32 s96, s96, 1
    s_cmp_gt_i32 s96, 0
    s_cbranch_scc1 L_lw_gh1
L_lwd_gh1:
    s_mov_b64 s[64:65], -1
    v_mov_b32 v192, -1
    s_mov_b64 s[66:67], -1
    v_mov_b32 v196, -1
    s_mov_b64 s[68:69], -1
    v_mov_b32 v200, -1
    s_mov_b64 s[70:71], -1
    v_mov_b32 v204, -1
    v_lshlrev_b32 v45, 8, v0
    v_add_u32 v45, 983040, v45
    v_mov_b32 v50, s61
    s_mov_b32 s76, 0
L_h2_poll:
    s_xor_b32 exec_lo, s76, 0xff
    s_mov_b32 exec_hi, 0
    s_cbranch_execz L_h2f22
    global_load_dword v50, v45, s[28:29] sc1
L_h2f22:
    s_bitcmp1_b32 s76, 0
    s_cselect_b32 exec_lo, s64, 0
    s_bitcmp1_b32 s76, 1
    s_cselect_b32 exec_hi, s65, 0
    s_cbranch_execz L_h2s23
    global_load_dwordx4 v[192:195], v40, s[28:29] sc1
L_h2s23:
    s_bitcmp1_b32 s76, 2
    s_cselect_b32 exec_lo, s66, 0
    s_bitcmp1_b32 s76, 3
    s_cselect_b32 exec_hi, s67, 0
    s_cbranch_execz L_h2s24
    global_load_dwordx4 v[196:199], v41, s[28:29] sc1
L_h2s24:
    s_bitcmp1_b32 s76, 4
    s_cselect_b32 exec_lo, s68, 0
    s_bitcmp1_b32 s76, 5
    s_cselect_b32 exec_hi, s69, 0
    s_cbranch_execz L_h2s25
    global_load_dwordx4 v[200:203], v42, s[28:29] sc1
L_h2s25:
    s_bitcmp1_b32 s76, 6
    s_cselect_b32 exec_lo, s70, 0
    s_bitcmp1_b32 s76, 7
    s_cselect_b32 exec_hi, s71, 0
    s_cbranch_execz L_h2s26
    global_load_dwordx4 v[204:207], v43, s[28:29] sc1
L_h2s26:
    s_mov_b64 exec, -1
    s_waitcnt vmcnt(0)
    v_cmp_eq_u32 s[76:77], s60, v50
    v_max3_u32 v8, v192, v193, v194
    v_max_u32 v8, v8, v195
    v_max3_u32 v9, v196, v197, v198
    v_max_u32 v9, v9, v199
    v_max3_u32 v10, v200, v201, v202
    v_max_u32 v10, v10, v203
    v_max3_u32 v11, v204, v205, v206
    v_max_u32 v11, v11, v207
    v_cmp_eq_u32 s[64:65], -1, v8
    v_cmp_eq_u32 s[66:67], -1, v9
    v_cmp_eq_u32 s[68:69], -1, v10
    v_cmp_eq_u32 s[70:71], -1, v11
    s_or_b64 s[72:73], s[64:65], s[66:67]
    s_or_b64 s[74:75], s[68:69], s[70:71]
    s_or_b64 s[72:73], s[72:73], s[74:75]
    s_cbranch_scc0 L_h2_done
    s_sub_u32 s96, s96, 1
    s_cmp_gt_i32 s96, 0
    s_cbranch_scc1 L_h2_poll
L_h2_done:
    v_lshlrev_b32 v64, 16, v192
    v_and_b32 v65, s57, v192
    v_lshlrev_b32 v66, 16, v193
    v_and_b32 v67, s57, v193
    v_lshlrev_b32 v68, 16, v194
    v_and_b32 v69, s57, v194
    v_lshlrev_b32 v70, 16, v195
    v_and_b32 v71, s57, v195
    v_lshlrev_b32 v72, 16, v196
    v_and_b32 v73, s57, v196
    v_lshlrev_b32 v74, 16, v197
    v_and_b32 v75, s57, v197
    v_lshlrev_b32 v76, 16, v198
    v_and_b32 v77, s57, v198
    v_lshlrev_b32 v78, 16, v199
    v_and_b32 v79, s57, v199
    v_pk_add_f32 v[64:65], v[64:65], v[72:73]
    v_pk_add_f32 v[66:67], v[66:67], v[74:75]
    v_pk_add_f32 v[68:69], v[68:69], v[76:77]
    v_pk_add_f32 v[70:71], v[70:71], v[78:79]
    v_lshlrev_b32 v80, 16, v200
    v_and_b32 v81, s57, v200
    v_lshlrev_b32 v82, 16, v201
    v_and_b32 v83, s57, v201
    v_lshlrev_b32 v84, 16, v202
    v_and_b32 v85, s57, v202
    v_lshlrev_b32 v86, 16, v203
    v_and_b32 v87, s57, v203
    v_lshlrev_b32 v88, 16, v204
    v_and_b32 v89, s57, v204
    v_lshlrev_b32 v90, 16, v205
    v_and_b32 v91, s57, v205
    v_lshlrev_b32 v92, 16, v206
    v_and_b32 v93, s57, v206
    v_lshlrev_b32 v94, 16, v207
    v_and_b32 v95, s57, v207
    v_pk_add_f32 v[80:81], v[80:81], v[88:89]
    v_pk_add_f32 v[82:83], v[82:83], v[90:91]
    v_pk_add_f32 v[84:85], v[84:85], v[92:93]
    v_pk_add_f32 v[86:87], v[86:87], v[94:95]
    v_pk_add_f32 v[64:65], v[64:65], v[80:81]
    v_pk_add_f32 v[66:67], v[66:67], v[82:83]
    v_pk_add_f32 v[68:69], v[68:69], v[84:85]
    v_pk_add_f32 v[70:71], v[70:71], v[86:87]
    s_nop 0
    v_permlane32_swap_b32 v64, v65
    v_permlane32_swap_b32 v66, v67
    v_permlane32_swap_b32 v68, v69
    v_permlane32_swap_b32 v70, v71
    v_add_f32 v64, v64, v65
    v_add_f32 v66, v66, v67
    v_add_f32 v68, v68, v69
    v_add_f32 v70, v70, v71
    s_nop 1
    v_permlane16_swap_b32 v64, v66
    v_permlane16_swap_b32 v68, v70
    v_add_f32 v8, v64, v66
    v_add_f32 v9, v68, v70
    s_nop 0
    v_add_f32_dpp v10, v8, v8 row_ror:8 row_mask:0xf bank_mask:0x3
    v_add_f32_dpp v10, v9, v9 row_ror:8 row_mask:0xf bank_mask:0xc
    s_nop 1
    v_add_f32_dpp v8, v10, v10 row_half_mirror row_mask:0xf bank_mask:0xf
    s_nop 1
    v_add_f32_dpp v8, v8, v8 quad_perm:[2,3,0,1] row_mask:0xf bank_mask:0xf
    s_nop 1
    v_add_f32_dpp v8, v8, v8 quad_perm:[1,0,3,2] row_mask:0xf bank_mask:0xf
    v_cvt_pk_bf16_f32 v8, v8, v8
    s_mov_b64 exec, s[78:79]
    global_store_short v44, v8, s[24:25]
L_g_fin:
    s_endpgm
L_consumer:
    v_and_b32 v2, 15, v0
    v_lshrrev_b32 v3, 4, v0
    v_lshlrev_b32 v4, 9, v2
    v_add_u32 v5, 0, v3
    v_xor_b32 v5, v5, v2
    v_lshl_add_u32 v8, v5, 4, v4
    v_add_u32 v5, 4, v3
    v_xor_b32 v5, v5, v2
    v_lshl_add_u32 v9, v5, 4, v4
    v_add_u32 v5, 8, v3
    v_xor_b32 v5, v5, v2
    v_lshl_add_u32 v10, v5, 4, v4
    v_add_u32 v5, 12, v3
    v_xor_b32 v5, v5, v2
    v_lshl_add_u32 v11, v5, 4, v4
    s_waitcnt lgkmcnt(0)
    s_barrier
    v_lshrrev_b32 v2, 2, v0
    v_lshlrev_b32 v4, 9, v2
    v_and_b32 v5, 3, v0
    v_lshl_add_u32 v4, v5, 3, v4
    v_and_b32 v2, 7, v2
    v_xor_b32 v5, 0, v2
    v_lshl_add_u32 v12, v5, 5, v4
    v_xor_b32 v5, 1, v2
    v_lshl_add_u32 v13, v5, 5, v4
    v_xor_b32 v5, 2, v2
    v_lshl_add_u32 v14, v5, 5, v4
    v_xor_b32 v5, 3, v2
    v_lshl_add_u32 v15, v5, 5, v4
    v_xor_b32 v5, 4, v2
    v_lshl_add_u32 v16, v5, 5, v4
    v_xor_b32 v5, 5, v2
    v_lshl_add_u32 v17, v5, 5, v4
    v_xor_b32 v5, 6, v2
    v_lshl_add_u32 v18, v5, 5, v4
    v_xor_b32 v5, 7, v2
    v_lshl_add_u32 v19, v5, 5, v4
    v_mov_b32 v64, 0
    v_mov_b32 v65, 0
    v_mov_b32 v66, 0
    v_mov_b32 v67, 0
    v_mov_b32 v68, 0
    v_mov_b32 v69, 0
    v_mov_b32 v70, 0
    v_mov_b32 v71, 0
    v_mov_b32 v72, 0
    v_mov_b32 v73, 0
    v_mov_b32 v74, 0
    v_mov_b32 v75, 0
    v_mov_b32 v76, 0
    v_mov_b32 v77, 0
    v_mov_b32 v78, 0
    v_mov_b32 v79, 0
    v_mov_b32 v80, 0
    v_mov_b32 v81, 0
    v_mov_b32 v82, 0
    v_mov_b32 v83, 0
    v_mov_b32 v84, 0
    v_mov_b32 v85, 0
    v_mov_b32 v86, 0
    v_mov_b32 v87, 0
    v_mov_b32 v88, 0
    v_mov_b32 v89, 0
    v_mov_b32 v90, 0
    v_mov_b32 v91, 0
    v_mov_b32 v92, 0
    v_mov_b32 v93, 0
    v_mov_b32 v94, 0
    v_mov_b32 v95, 0
    v_mov_b32 v200, 0xff61b1e6
    v_mov_b32 v201, 0
    v_mov_b32 v204, 0
    v_mov_b32 v205, 162816
    s_lshl_b32 s49, s30, 2
    s_add_u32 s49, s49, 163324
    v_mov_b32 v206, s49
    s_mov_b32 s57, 0x3db8aa3b
    s_mov_b32 s58, 0xffff0000
    v_and_b32 v1, 1, v0
    v_lshlrev_b32 v1, 9, v1
    v_and_b32 v3, 48, v0
    v_add_u32 v1, v1, v3
    v_add_u32 v1, 161792, v1
    s_sub_u32 s50, s30, 1
    s_lshl_b32 s54, s50, 14
    s_mov_b32 s51, -64
    s_mov_b32 s52, -1
    s_lshl_b32 s48, s30, 11
    s_add_u32 s48, s48, 153600
    v_and_b32 v2, 1, v0
    v_lshl_add_u32 v210, v0, 4, s48
    s_lshl_b32 s48, s30, 4
    s_add_u32 s48, s48, 163408
    v_lshl_add_u32 v211, v2, 3, s48
    v_mov_b32 v212, 163344
    v_mov_b32 v213, 1
    s_mov_b32 s62, 0x00030003
    s_mov_b32 s63, 0x00030003
    s_lshl_b32 s48, s31, 16
    s_lshl_b32 s49, s3, 6
    s_add_u32 s48, s48, s49
    s_add_u32 s48, s48, 1048576
    v_lshrrev_b32 v3, 2, v0
    v_lshlrev_b32 v3, 11, v3
    v_and_b32 v4, 3, v0
    v_lshl_add_u32 v3, v4, 4, v3
    v_add_u32 v214, s48, v3
    v_add_u32 v215, 32768, v214
    v_lshlrev_b32 v216, 4, v0
    v_add_u32 v216, 155648, v216
    v_and_b32 v3, 48, v0
    v_lshl_add_u32 v218, v2, 6, v3
    v_add_u32 v218, 147456, v218
    v_and_b32 v217, 1, v0
    v_lshlrev_b32 v217, 2, v217
    v_add_u32 v217, 163376, v217
    s_lshl_b32 s53, s50, 1
    s_add_u32 s53, s53, 2
    s_cmp_ge_i32 s51, s53
    s_cbranch_scc1 L_c_go0
L_c_wait0:
    ds_read_b64 v[2:3], v205
    s_waitcnt lgkmcnt(0)
    v_readfirstlane_b32 s51, v2
    v_readfirstlane_b32 s52, v3
    s_cmp_ge_i32 s51, s53
    s_cbranch_scc1 L_c_go0
    s_sleep 1
    s_sub_u32 s96, s96, 1
    s_cmp_gt_i32 s96, 0
    s_cbranch_scc1 L_c_wait0
L_c_go0:
    v_add_u32 v20, s54, v8
    v_add_u32 v21, s54, v9
    v_add_u32 v22, s54, v10
    v_add_u32 v23, s54, v11
    ds_read_b128 v[128:131], v20 offset:0
    ds_read_b128 v[132:135], v21 offset:0
    ds_read_b128 v[136:139], v22 offset:0
    ds_read_b128 v[140:143], v23 offset:0
    ds_read_b128 v[144:147], v20 offset:256
    ds_read_b128 v[148:151], v21 offset:256
    ds_read_b128 v[152:155], v22 offset:256
    ds_read_b128 v[156:159], v23 offset:256
    ds_read_b128 v[160:163], v20 offset:8192
    ds_read_b128 v[164:167], v21 offset:8192
    ds_read_b128 v[168:171], v22 offset:8192
    ds_read_b128 v[172:175], v23 offset:8192
    ds_read_b128 v[176:179], v20 offset:8448
    ds_read_b128 v[180:183], v21 offset:8448
    ds_read_b128 v[184:187], v22 offset:8448
    s_lshl_b32 s48, s50, 7
    v_add_u32 v219, s48, v218
    s_add_u32 s50, s50, 3
    v_mov_b32 v207, s50
    s_add_u32 s54, s54, 49152
    s_cmp_ge_u32 s54, 147456
    s_cselect_b32 s55, 147456, 0
    s_sub_u32 s54, s54, s55
    s_waitcnt lgkmcnt(14)
    ds_read_b128 v[188:191], v23 offset:8448
    s_waitcnt lgkmcnt(0)
    ds_write_b32 v206, v207
    v_mov_b32 v2, 163340
L_lw_cq:
    ds_read_b32 v3, v2
    s_waitcnt lgkmcnt(0)
    v_readfirstlane_b32 s48, v3
    s_cmp_eq_u32 s48, 2
    s_cbranch_scc1 L_lwd_cq
    s_sleep 1
    s_sub_u32 s96, s96, 1
    s_cmp_gt_i32 s96, 0
    s_cbranch_scc1 L_lw_cq
L_lwd_cq:
    ds_read_b128 v[32:35], v1 offset:0
    ds_read_b128 v[36:39], v1 offset:64
    ds_read_b128 v[40:43], v1 offset:128
    ds_read_b128 v[44:47], v1 offset:192
    ds_read_b128 v[48:51], v1 offset:256
    ds_read_b128 v[52:55], v1 offset:320
    ds_read_b128 v[56:59], v1 offset:384
    ds_read_b128 v[60:63], v1 offset:448
    ds_read_b32 v3, v212 offset:4
    s_waitcnt lgkmcnt(0)
    v_readfirstlane_b32 s60, v3
    s_branch L_c_kcomp
L_c_kloop:
    s_lshl_b32 s53, s50, 1
    s_add_u32 s53, s53, 2
    s_cmp_ge_i32 s51, s53
    s_cbranch_scc1 L_c_gokk
L_c_waitkk:
    ds_read_b64 v[2:3], v205
    s_waitcnt lgkmcnt(0)
    v_readfirstlane_b32 s51, v2
    v_readfirstlane_b32 s52, v3
    s_cmp_ge_i32 s51, s53
    s_cbranch_scc1 L_c_gokk
    s_sleep 1
    s_sub_u32 s96, s96, 1
    s_cmp_gt_i32 s96, 0
    s_cbranch_scc1 L_c_waitkk
L_c_gokk:
    v_add_u32 v20, s54, v8
    v_add_u32 v21, s54, v9
    v_add_u32 v22, s54, v10
    v_add_u32 v23, s54, v11
    ds_read_b128 v[128:131], v20 offset:0
    ds_read_b128 v[132:135], v21 offset:0
    ds_read_b128 v[136:139], v22 offset:0
    ds_read_b128 v[140:143], v23 offset:0
    ds_read_b128 v[144:147], v20 offset:256
    ds_read_b128 v[148:151], v21 offset:256
    ds_read_b128 v[152:155], v22 offset:256
    ds_read_b128 v[156:159], v23 offset:256
    ds_read_b128 v[160:163], v20 offset:8192
    ds_read_b128 v[164:167], v21 offset:8192
    ds_read_b128 v[168:171], v22 offset:8192
    ds_read_b128 v[172:175], v23 offset:8192
    ds_read_b128 v[176:179], v20 offset:8448
    ds_read_b128 v[180:183], v21 offset:8448
    ds_read_b128 v[184:187], v22 offset:8448
    s_lshl_b32 s48, s50, 7
    v_add_u32 v219, s48, v218
    s_add_u32 s50, s50, 3
    v_mov_b32 v207, s50
    s_add_u32 s54, s54, 49152
    s_cmp_ge_u32 s54, 147456
    s_cselect_b32 s55, 147456, 0
    s_sub_u32 s54, s54, s55
    s_waitcnt lgkmcnt(14)
    ds_read_b128 v[188:191], v23 offset:8448
    s_waitcnt lgkmcnt(0)
    ds_write_b32 v206, v207
L_c_kcomp:
    v_mfma_f32_16x16x32_bf16 v[192:195], v[128:131], v[32:35], 0
    v_mfma_f32_16x16x32_bf16 v[196:199], v[160:163], v[32:35], 0
    v_mfma_f32_16x16x32_bf16 v[192:195], v[132:135], v[36:39], v[192:195]
    v_mfma_f32_16x16x32_bf16 v[196:199], v[164:167], v[36:39], v[196:199]
    v_mfma_f32_16x16x32_bf16 v[192:195], v[136:139], v[40:43], v[192:195]
    v_mfma_f32_16x16x32_bf16 v[196:199], v[168:171], v[40:43], v[196:199]
    v_mfma_f32_16x16x32_bf16 v[192:195], v[140:143], v[44:47], v[192:195]
    v_mfma_f32_16x16x32_bf16 v[196:199], v[172:175], v[44:47], v[196:199]
    v_mfma_f32_16x16x32_bf16 v[192:195], v[144:147], v[48:51], v[192:195]
    v_mfma_f32_16x16x32_bf16 v[196:199], v[176:179], v[48:51], v[196:199]
    v_mfma_f32_16x16x32_bf16 v[192:195], v[148:151], v[52:55], v[192:195]
    v_mfma_f32_16x16x32_bf16 v[196:199], v[180:183], v[52:55], v[196:199]
    v_mfma_f32_16x16x32_bf16 v[192:195], v[152:155], v[56:59], v[192:195]
    v_mfma_f32_16x16x32_bf16 v[196:199], v[184:187], v[56:59], v[196:199]
    v_mfma_f32_16x16x32_bf16 v[192:195], v[156:159], v[60:63], v[192:195]
    v_mfma_f32_16x16x32_bf16 v[196:199], v[188:191], v[60:63], v[196:199]
    s_nop 7
    s_nop 1
    v_cvt_pk_bf16_f32 v220, v192, v193
    v_cvt_pk_bf16_f32 v221, v194, v195
    v_cvt_pk_bf16_f32 v222, v196, v197
    v_cvt_pk_bf16_f32 v223, v198, v199
    s_mov_b64 exec, s[62:63]
    ds_write_b128 v219, v[220:223]
    s_mov_b64 exec, -1
    v_lshlrev_b32 v192, 16, v220
    v_and_b32 v193, s58, v220
    v_lshlrev_b32 v194, 16, v221
    v_and_b32 v195, s58, v221
    v_lshlrev_b32 v196, 16, v222
    v_and_b32 v197, s58, v222
    v_lshlrev_b32 v198, 16, v223
    v_and_b32 v199, s58, v223
    v_max3_f32 v202, v192, v193, v194
    v_max3_f32 v203, v195, v196, v197
    v_max3_f32 v202, v202, v198, v199
    v_max3_f32 v202, v202, v203, v200
    v_sub_f32 v203, v200, v202
    v_sub_f32 v192, v192, v202
    v_sub_f32 v193, v193, v202
    v_sub_f32 v194, v194, v202
    v_sub_f32 v195, v195, v202
    v_sub_f32 v196, v196, v202
    v_sub_f32 v197, v197, v202
    v_sub_f32 v198, v198, v202
    v_sub_f32 v199, v199, v202
    v_mul_f32 v203, s57, v203
    v_mul_f32 v192, s57, v192
    v_mul_f32 v193, s57, v193
    v_mul_f32 v194, s57, v194
    v_mul_f32 v195, s57, v195
    v_mul_f32 v196, s57, v196
    v_mul_f32 v197, s57, v197
    v_mul_f32 v198, s57, v198
    v_mul_f32 v199, s57, v199
    v_exp_f32 v203, v203
    v_exp_f32 v192, v192
    v_exp_f32 v193, v193
    v_exp_f32 v194, v194
    v_exp_f32 v195, v195
    v_exp_f32 v196, v196
    v_exp_f32 v197, v197
    v_exp_f32 v198, v198
    v_exp_f32 v199, v199
    v_mov_b32 v200, v202
    v_pk_add_f32 v[192:193], v[192:193], v[194:195]
    v_pk_add_f32 v[196:197], v[196:197], v[198:199]
    v_pk_add_f32 v[192:193], v[192:193], v[196:197]
    v_fma_f32 v201, v201, v203, v192
    v_add_f32 v201, v201, v193
    s_cmp_lt_u32 s50, 64
    s_cbranch_scc1 L_c_kloop
    v_mov_b32 v202, v200
    v_mov_b32 v203, v202
    s_nop 1
    v_permlane16_swap_b32 v202, v203
    v_max_f32 v202, v202, v203
    v_mov_b32 v203, v202
    s_nop 1
    v_permlane32_swap_b32 v202, v203
    v_max_f32 v202, v202, v203
    v_sub_f32 v203, v200, v202
    v_mul_f32 v203, s57, v203
    v_exp_f32 v203, v203
    v_mov_b32 v200, v202
    v_mul_f32 v201, v201, v203
    v_mul_f32 v204, s57, v202
    v_mov_b32 v203, v201
    s_nop 1
    v_permlane16_swap_b32 v201, v203
    v_add_f32 v201, v201, v203
    v_mov_b32 v203, v201
    s_nop 1
    v_permlane32_swap_b32 v201, v203
    v_add_f32 v201, v201, v203
    s_mov_b64 exec, 3
    ds_write_b64 v211, v[200:201]
    s_mov_b64 exec, -1
L_c_vloop:
    s_sub_u32 s48, s50, 51
    s_lshl_b32 s48, s48, 7
    s_lshr_b32 s49, s54, 7
    s_cmp_lt_u32 s50, 115
    s_cselect_b32 s48, s48, s49
    v_add_u32 v219, s48, v218
    v_add_u32 v24, s54, v12
    v_add_u32 v25, s54, v13
    v_add_u32 v26, s54, v14
    v_add_u32 v27, s54, v15
    v_add_u32 v28, s54, v16
    v_add_u32 v29, s54, v17
    v_add_u32 v30, s54, v18
    v_add_u32 v31, s54, v19
    s_lshl_b32 s53, s50, 1
    s_add_u32 s53, s53, 1
    s_cmp_ge_i32 s51, s53
    s_cbranch_scc1 L_c_gova
    s_cmp_ge_u32 s50, s52
    s_cbranch_scc1 L_c_end
L_c_waitva:
    ds_read_b64 v[2:3], v205
    s_waitcnt lgkmcnt(0)
    v_readfirstlane_b32 s51, v2
    v_readfirstlane_b32 s52, v3
    s_cmp_ge_i32 s51, s53
    s_cbranch_scc1 L_c_gova
    s_cmp_ge_u32 s50, s52
    s_cbranch_scc1 L_c_end
    s_sleep 1
    s_sub_u32 s96, s96, 1
    s_cmp_gt_i32 s96, 0
    s_cbranch_scc1 L_c_waitva
    s_branch L_c_end
L_c_gova:
    ds_read_b32 v201, v217
    ds_read_b128 v[220:223], v219
    ds_read_b64_tr_b16 v[128:129], v24 offset:0
    ds_read_b64_tr_b16 v[132:133], v25 offset:0
    ds_read_b64_tr_b16 v[136:137], v26 offset:0
    ds_read_b64_tr_b16 v[140:141], v27 offset:0
    ds_read_b64_tr_b16 v[144:145], v28 offset:0
    ds_read_b64_tr_b16 v[148:149], v29 offset:0
    ds_read_b64_tr_b16 v[152:153], v30 offset:0
    ds_read_b64_tr_b16 v[156:157], v31 offset:0
    ds_read_b64_tr_b16 v[160:161], v24 offset:256
    ds_read_b64_tr_b16 v[164:165], v25 offset:256
    ds_read_b64_tr_b16 v[168:169], v26 offset:256
    ds_read_b64_tr_b16 v[172:173], v27 offset:256
    ds_read_b64_tr_b16 v[176:177], v28 offset:256
    s_waitcnt lgkmcnt(12)
    ds_read_b64_tr_b16 v[180:181], v29 offset:256
    ds_read_b64_tr_b16 v[184:185], v30 offset:256
    ds_read_b64_tr_b16 v[188:189], v31 offset:256
    v_lshlrev_b32 v192, 16, v220
    v_and_b32 v193, s58, v220
    v_lshlrev_b32 v194, 16, v221
    v_and_b32 v195, s58, v221
    v_lshlrev_b32 v196, 16, v222
    v_and_b32 v197, s58, v222
    v_lshlrev_b32 v198, 16, v223
    v_and_b32 v199, s58, v223
    v_max3_f32 v202, v192, v193, v194
    v_max3_f32 v203, v195, v196, v197
    v_max3_f32 v202, v202, v198, v199
    v_max3_f32 v202, v202, v203, v201
    v_cmp_gt_f32 vcc, v202, v200
    s_cbranch_vccz L_c_vnors
    v_max_f32 v202, v202, v200
    v_mov_b32 v203, v202
    s_nop 1
    v_permlane16_swap_b32 v202, v203
    v_max_f32 v202, v202, v203
    v_mov_b32 v203, v202
    s_nop 1
    v_permlane32_swap_b32 v202, v203
    v_max_f32 v202, v202, v203
    v_sub_f32 v203, v200, v202
    v_mul_f32 v203, s57, v203
    v_exp_f32 v208, v203
    v_mov_b32 v200, v202
    v_mul_f32 v204, s57, v202
    s_nop 0
    v_mov_b32_dpp v209, v208 quad_perm:[1,1,1,1] row_mask:0xf bank_mask:0xf
    v_mov_b32_dpp v208, v208 quad_perm:[0,0,0,0] row_mask:0xf bank_mask:0xf
    v_pk_mul_f32 v[64:65], v[64:65], v[208:209]
    v_pk_mul_f32 v[68:69], v[68:69], v[208:209]
    v_pk_mul_f32 v[72:73], v[72:73], v[208:209]
    v_pk_mul_f32 v[76:77], v[76:77], v[208:209]
L_c_vnors:
    s_cmp_gt_i32 s51, s53
    s_cbranch_scc0 L_c_vlate
    s_waitcnt lgkmcnt(0)
    ds_read_b64_tr_b16 v[130:131], v24 offset:8192
    ds_read_b64_tr_b16 v[134:135], v25 offset:8192
    ds_read_b64_tr_b16 v[138:139], v26 offset:8192
    ds_read_b64_tr_b16 v[142:143], v27 offset:8192
    ds_read_b64_tr_b16 v[146:147], v28 offset:8192
    ds_read_b64_tr_b16 v[150:151], v29 offset:8192
    ds_read_b64_tr_b16 v[154:155], v30 offset:8192
    ds_read_b64_tr_b16 v[158:159], v31 offset:8192
    ds_read_b64_tr_b16 v[162:163], v24 offset:8448
    ds_read_b64_tr_b16 v[166:167], v25 offset:8448
    ds_read_b64_tr_b16 v[170:171], v26 offset:8448
    ds_read_b64_tr_b16 v[174:175], v27 offset:8448
    ds_read_b64_tr_b16 v[178:179], v28 offset:8448
    ds_read_b64_tr_b16 v[182:183], v29 offset:8448
    ds_read_b64_tr_b16 v[186:187], v30 offset:8448
    v_pk_add_f32 v[192:193], v[192:193], v[200:201] op_sel_hi:[1,0] neg_lo:[0,1] neg_hi:[0,1]
    v_pk_add_f32 v[194:195], v[194:195], v[200:201] op_sel_hi:[1,0] neg_lo:[0,1] neg_hi:[0,1]
    v_pk_add_f32 v[196:197], v[196:197], v[200:201] op_sel_hi:[1,0] neg_lo:[0,1] neg_hi:[0,1]
    v_pk_add_f32 v[198:199], v[198:199], v[200:201] op_sel_hi:[1,0] neg_lo:[0,1] neg_hi:[0,1]
    v_pk_mul_f32 v[192:193], v[192:193], s[56:57] op_sel:[0,1] op_sel_hi:[1,1]
    v_pk_mul_f32 v[194:195], v[194:195], s[56:57] op_sel:[0,1] op_sel_hi:[1,1]
    v_pk_mul_f32 v[196:197], v[196:197], s[56:57] op_sel:[0,1] op_sel_hi:[1,1]
    v_pk_mul_f32 v[198:199], v[198:199], s[56:57] op_sel:[0,1] op_sel_hi:[1,1]
    v_exp_f32 v192, v192
    v_exp_f32 v193, v193
    v_exp_f32 v194, v194
    v_exp_f32 v195, v195
    v_exp_f32 v196, v196
    v_exp_f32 v197, v197
    v_exp_f32 v198, v198
    v_exp_f32 v199, v199
    s_nop 0
    v_cvt_pk_bf16_f32 v220, v192, v193
    v_cvt_pk_bf16_f32 v221, v194, v195
    v_cvt_pk_bf16_f32 v222, v196, v197
    v_cvt_pk_bf16_f32 v223, v198, v199
    s_lshl_b64 exec, s[62:63], 0
    v_mov_b64 v[80:81], v[220:221]
    v_mov_b64 v[82:83], v[222:223]
    s_lshl_b64 exec, s[62:63], 4
    v_mov_b64 v[84:85], v[220:221]
    v_mov_b64 v[86:87], v[222:223]
    s_lshl_b64 exec, s[62:63], 8
    v_mov_b64 v[88:89], v[220:221]
    v_mov_b64 v[90:91], v[222:223]
    s_lshl_b64 exec, s[62:63], 12
    v_mov_b64 v[92:93], v[220:221]
    v_mov_b64 v[94:95], v[222:223]
    s_mov_b64 exec, -1
    s_branch L_c_pv
L_c_vlate:
    v_pk_add_f32 v[192:193], v[192:193], v[200:201] op_sel_hi:[1,0] neg_lo:[0,1] neg_hi:[0,1]
    v_pk_add_f32 v[194:195], v[194:195], v[200:201] op_sel_hi:[1,0] neg_lo:[0,1] neg_hi:[0,1]
    v_pk_add_f32 v[196:197], v[196:197], v[200:201] op_sel_hi:[1,0] neg_lo:[0,1] neg_hi:[0,1]
    v_pk_add_f32 v[198:199], v[198:199], v[200:201] op_sel_hi:[1,0] neg_lo:[0,1] neg_hi:[0,1]
    v_pk_mul_f32 v[192:193], v[192:193], s[56:57] op_sel:[0,1] op_sel_hi:[1,1]
    v_pk_mul_f32 v[194:195], v[194:195], s[56:57] op_sel:[0,1] op_sel_hi:[1,1]
    v_pk_mul_f32 v[196:197], v[196:197], s[56:57] op_sel:[0,1] op_sel_hi:[1,1]
    v_pk_mul_f32 v[198:199], v[198:199], s[56:57] op_sel:[0,1] op_sel_hi:[1,1]
    v_exp_f32 v192, v192
    v_exp_f32 v193, v193
    v_exp_f32 v194, v194
    v_exp_f32 v195, v195
    v_exp_f32 v196, v196
    v_exp_f32 v197, v197
    v_exp_f32 v198, v198
    v_exp_f32 v199, v199
    s_nop 0
    v_cvt_pk_bf16_f32 v220, v192, v193
    v_cvt_pk_bf16_f32 v221, v194, v195
    v_cvt_pk_bf16_f32 v222, v196, v197
    v_cvt_pk_bf16_f32 v223, v198, v199
    s_lshl_b64 exec, s[62:63], 0
    v_mov_b64 v[80:81], v[220:221]
    v_mov_b64 v[82:83], v[222:223]
    s_lshl_b64 exec, s[62:63], 4
    v_mov_b64 v[84:85], v[220:221]
    v_mov_b64 v[86:87], v[222:223]
    s_lshl_b64 exec, s[62:63], 8
    v_mov_b64 v[88:89], v[220:221]
    v_mov_b64 v[90:91], v[222:223]
    s_lshl_b64 exec, s[62:63], 12
    v_mov_b64 v[92:93], v[220:221]
    v_mov_b64 v[94:95], v[222:223]
    s_mov_b64 exec, -1
    s_waitcnt lgkmcnt(0)
    s_lshl_b32 s53, s50, 1
    s_add_u32 s53, s53, 2
    s_cmp_ge_i32 s51, s53
    s_cbranch_scc1 L_c_govb
L_c_waitvb:
    ds_read_b64 v[2:3], v205
    s_waitcnt lgkmcnt(0)
    v_readfirstlane_b32 s51, v2
    v_readfirstlane_b32 s52, v3
    s_cmp_ge_i32 s51, s53
    s_cbranch_scc1 L_c_govb
    s_sub_u32 s96, s96, 1
    s_cmp_gt_i32 s96, 0
    s_cbranch_scc1 L_c_waitvb
L_c_govb:
    ds_read_b64_tr_b16 v[130:131], v24 offset:8192
    ds_read_b64_tr_b16 v[134:135], v25 offset:8192
    ds_read_b64_tr_b16 v[138:139], v26 offset:8192
    ds_read_b64_tr_b16 v[142:143], v27 offset:8192
    ds_read_b64_tr_b16 v[146:147], v28 offset:8192
    ds_read_b64_tr_b16 v[150:151], v29 offset:8192
    ds_read_b64_tr_b16 v[154:155], v30 offset:8192
    ds_read_b64_tr_b16 v[158:159], v31 offset:8192
    ds_read_b64_tr_b16 v[162:163], v24 offset:8448
    ds_read_b64_tr_b16 v[166:167], v25 offset:8448
    ds_read_b64_tr_b16 v[170:171], v26 offset:8448
    ds_read_b64_tr_b16 v[174:175], v27 offset:8448
    ds_read_b64_tr_b16 v[178:179], v28 offset:8448
    ds_read_b64_tr_b16 v[182:183], v29 offset:8448
    ds_read_b64_tr_b16 v[186:187], v30 offset:8448
L_c_pv:
    s_add_u32 s50, s50, 3
    v_mov_b32 v207, s50
    s_add_u32 s54, s54, 49152
    s_cmp_ge_u32 s54, 147456
    s_cselect_b32 s55, 147456, 0
    s_sub_u32 s54, s54, s55
    s_waitcnt lgkmcnt(14)
    ds_read_b64_tr_b16 v[190:191], v31 offset:8448
    v_mfma_f32_16x16x32_bf16 v[64:67], v[80:83], v[128:131], v[64:67]
    s_waitcnt lgkmcnt(14)
    v_mfma_f32_16x16x32_bf16 v[64:67], v[84:87], v[132:135], v[64:67]
    s_waitcnt lgkmcnt(13)
    v_mfma_f32_16x16x32_bf16 v[64:67], v[88:91], v[136:139], v[64:67]
    s_waitcnt lgkmcnt(12)
    v_mfma_f32_16x16x32_bf16 v[64:67], v[92:95], v[140:143], v[64:67]
    s_waitcnt lgkmcnt(11)
    v_mfma_f32_16x16x32_bf16 v[68:71], v[80:83], v[144:147], v[68:71]
    s_waitcnt lgkmcnt(10)
    v_mfma_f32_16x16x32_bf16 v[68:71], v[84:87], v[148:151], v[68:71]
    s_waitcnt lgkmcnt(9)
    v_mfma_f32_16x16x32_bf16 v[68:71], v[88:91], v[152:155], v[68:71]
    s_waitcnt lgkmcnt(8)
    v_mfma_f32_16x16x32_bf16 v[68:71], v[92:95], v[156:159], v[68:71]
    s_waitcnt lgkmcnt(7)
    v_mfma_f32_16x16x32_bf16 v[72:75], v[80:83], v[160:163], v[72:75]
    s_waitcnt lgkmcnt(6)
    v_mfma_f32_16x16x32_bf16 v[72:75], v[84:87], v[164:167], v[72:75]
    s_waitcnt lgkmcnt(5)
    v_mfma_f32_16x16x32_bf16 v[72:75], v[88:91], v[168:171], v[72:75]
    s_waitcnt lgkmcnt(4)
    v_mfma_f32_16x16x32_bf16 v[72:75], v[92:95], v[172:175], v[72:75]
    s_waitcnt lgkmcnt(3)
    v_mfma_f32_16x16x32_bf16 v[76:79], v[80:83], v[176:179], v[76:79]
    s_waitcnt lgkmcnt(2)
    v_mfma_f32_16x16x32_bf16 v[76:79], v[84:87], v[180:183], v[76:79]
    s_waitcnt lgkmcnt(1)
    v_mfma_f32_16x16x32_bf16 v[76:79], v[88:91], v[184:187], v[76:79]
    s_waitcnt lgkmcnt(0)
    v_mfma_f32_16x16x32_bf16 v[76:79], v[92:95], v[188:191], v[76:79]
    ds_write_b32 v206, v207
    s_cmp_lt_u32 s50, s52
    s_cbranch_scc1 L_c_vloop
    s_cmp_ge_u32 s50, 118
    s_cbranch_scc1 L_c_fin
L_c_end:
    ds_read_b32 v202, v217
    s_waitcnt lgkmcnt(0)
    s_nop 3
    v_cmp_gt_f32 vcc, v202, v200
    s_cbranch_vccz L_c_fin
    v_max_f32 v202, v202, v200
    v_mov_b32 v203, v202
    s_nop 1
    v_permlane16_swap_b32 v202, v203
    v_max_f32 v202, v202, v203
    v_mov_b32 v203, v202
    s_nop 1
    v_permlane32_swap_b32 v202, v203
    v_max_f32 v202, v202, v203
    v_sub_f32 v203, v200, v202
    v_mul_f32 v203, s57, v203
    v_exp_f32 v208, v203
    v_mov_b32 v200, v202
    v_mul_f32 v204, s57, v202
    s_nop 0
    v_mov_b32_dpp v209, v208 quad_perm:[1,1,1,1] row_mask:0xf bank_mask:0xf
    v_mov_b32_dpp v208, v208 quad_perm:[0,0,0,0] row_mask:0xf bank_mask:0xf
    v_pk_mul_f32 v[64:65], v[64:65], v[208:209]
    v_pk_mul_f32 v[68:69], v[68:69], v[208:209]
    v_pk_mul_f32 v[72:73], v[72:73], v[208:209]
    v_pk_mul_f32 v[76:77], v[76:77], v[208:209]
L_c_fin:
    v_mov_b32 v96, v64
    v_mov_b32 v100, v65
    v_mov_b32 v97, v68
    v_mov_b32 v101, v69
    v_mov_b32 v98, v72
    v_mov_b32 v102, v73
    v_mov_b32 v99, v76
    v_mov_b32 v103, v77
    ds_write_b128 v210, v[96:99]
    ds_write_b128 v210, v[100:103] offset:1024
    s_mov_b64 exec, 1
    ds_add_rtn_u32 v6, v212, v213
    s_mov_b64 exec, -1
    ds_read_b128 v[32:35], v216 offset:0
    ds_read_b128 v[40:43], v216 offset:2048
    ds_read_b128 v[48:51], v216 offset:4096
    ds_read_b128 v[36:39], v216 offset:1024
    ds_read_b128 v[44:47], v216 offset:3072
    ds_read_b128 v[52:55], v216 offset:5120
    s_waitcnt lgkmcnt(6)
    v_readfirstlane_b32 s48, v6
    s_cmp_eq_u32 s48, 2
    s_cbranch_scc0 L_exit
    s_waitcnt lgkmcnt(3)
    v_pk_add_f32 v[32:33], v[32:33], v[40:41]
    v_pk_add_f32 v[34:35], v[34:35], v[42:43]
    v_pk_add_f32 v[32:33], v[32:33], v[48:49]
    v_pk_add_f32 v[34:35], v[34:35], v[50:51]
    global_store_dwordx4 v214, v[32:35], s[28:29] sc1
    s_waitcnt lgkmcnt(0)
    v_pk_add_f32 v[36:37], v[36:37], v[44:45]
    v_pk_add_f32 v[38:39], v[38:39], v[46:47]
    v_pk_add_f32 v[36:37], v[36:37], v[52:53]
    v_pk_add_f32 v[38:39], v[38:39], v[54:55]
    global_store_dwordx4 v215, v[36:39], s[28:29] sc1
    s_endpgm
L_exit:
    s_endpgm
.section .rodata,"a"
.p2align 6
.amdhsa_kernel gated_mix__gqa_block_cached__swiglu_ffn__decode_kernel
  .amdhsa_next_free_vgpr 256
  .amdhsa_next_free_sgpr 102
  .amdhsa_accum_offset 256
  .amdhsa_group_segment_fixed_size 0
  .amdhsa_kernarg_size 104
  .amdhsa_user_sgpr_count 2
  .amdhsa_user_sgpr_kernarg_segment_ptr 1
  .amdhsa_system_sgpr_workgroup_id_x 1
.end_amdhsa_kernel
```
